```python
import torch

def _softmax(x, axis=-1):
    return torch.softmax(x, dim=axis)
def _gelu(x):
    return torch.nn.functional.gelu(x, approximate="tanh")
def _silu(x):
    return torch.nn.functional.silu(x)
def _sigmoid(x):
    return torch.sigmoid(x)
def _layernorm(x, axis=-1, eps=1e-5):
    m = x.mean(dim=axis, keepdim=True)
    v = x.var(dim=axis, keepdim=True, unbiased=False)
    return (x - m) / torch.sqrt(v + eps)
def _scatter_add(tgt, idx, src, axis=0):
    return tgt.clone().index_add_(axis, idx, src)
def _segment_sum(src, seg, n):
    out = torch.zeros((n,) + src.shape[1:], dtype=src.dtype)
    return out.index_add_(0, seg, src)
def _pad(x, pw):
    flat = tuple(v for pair in reversed(pw) for v in pair)
    return torch.nn.functional.pad(x, flat)

kernel_name = 'standalone__mha_block_cached__decode'

def setup_inputs():

    _w = (lambda a: (lambda t: t.to(torch.bfloat16) if t.is_floating_point() else t)(torch.as_tensor(a)))
    B, Sq, D = 4, 1, 448
    H, Sk, Dh = 16, 8192, 256
    return {
        "x": _w((lambda *s: torch.randn(*s, dtype=torch.bfloat16) * 0.8)(B, Sq, D)),
        "k_cache": _w((lambda *s: torch.randn(*s, dtype=torch.bfloat16) * 0.8)(B, H, Sk, Dh)),
        "v_cache": _w((lambda *s: torch.randn(*s, dtype=torch.bfloat16) * 0.05)(B, H, Sk, Dh)),
        "wq": _w((lambda *s: torch.randn(*s, dtype=torch.bfloat16) * 0.8)(D, H * Dh) * (D ** -0.5)),
        "wo": _w((lambda *s: torch.randn(*s, dtype=torch.bfloat16) * 0.05)(H * Dh, D) * ((H * Dh) ** -0.5)),
    }

def reference(x, k_cache, v_cache, wq, wo):
    B, Sq, D = x.shape
    H, Dh = 16, 256
    q = (lambda x, *d: x.permute(*d))((x @ wq).reshape(B, Sq, H, Dh), 0, 2, 1, 3)
    scores = torch.einsum("bhqd,bhkd->bhqk", q, k_cache) * (Dh ** -0.5)
    p = _softmax(scores, axis=-1)
    o = torch.einsum("bhqk,bhkd->bhqd", p, v_cache)
    return (lambda x, *d: x.permute(*d))(o, 0, 2, 1, 3).reshape(B, Sq, H * Dh) @ wo
```

```asm
; @launch grid=(256,1,1) block=(256,1,1) lds=49152
.amdgcn_target "amdgcn-amd-amdhsa--gfx950"
.text
.globl standalone__mha_block_cached__decode_kernel
.p2align 8
.type standalone__mha_block_cached__decode_kernel,@function
standalone__mha_block_cached__decode_kernel:
    s_cmp_ge_u32 s2, 256
    s_cbranch_scc1 L_end
    s_load_dwordx16 s[4:19], s[0:1], 0
    v_lshrrev_b32 v6, 6, v0
    v_and_b32 v1, 63, v0
    v_readfirstlane_b32 s3, v6
    s_and_b32 s48, s2, 7
    s_lshl_b32 s48, s48, 1
    s_bfe_u32 s53, s2, 0x10003
    s_add_u32 s48, s48, s53
    s_bfe_u32 s50, s2, 0x20004
    s_lshr_b32 s49, s2, 6
    s_lshl_b32 s51, s49, 6
    s_lshl_b32 s53, s48, 2
    s_add_u32 s51, s51, s53
    s_add_u32 s51, s51, s50
    s_mov_b32 s55, 0x3db8aa3b
    s_lshl_b32 s76, s49, 2
    s_add_u32 s76, s76, s50
    s_and_b32 s76, s76, 15
    v_lshrrev_b32 v13, 4, v1
    v_and_b32 v14, 15, v1
    v_and_b32 v15, 3, v1
    v_bfe_u32 v11, v1, 2, 2
    v_lshlrev_b32 v2, 9, v11
    v_lshl_add_u32 v2, v13, 6, v2
    v_lshl_add_u32 v2, v15, 4, v2
    v_lshlrev_b32 v3, 9, v13
    v_lshl_add_u32 v3, v14, 4, v3
    s_lshl_b32 s53, s3, 12
    v_add_u32 v2, s53, v2
    v_add_u32 v3, s53, v3
    v_bfe_u32 v6, v1, 3, 1
    v_lshl_add_u32 v6, v13, 1, v6
    v_mul_u32_u24 v4, 114688, v6
    v_and_b32 v10, 7, v1
    v_lshl_add_u32 v4, v10, 4, v4
    s_mul_i32 s66, s3, 917504
    s_lshl_b32 s53, s50, 7
    s_add_u32 s66, s66, s53
    s_mul_i32 s67, s3, 224
    s_mul_i32 s53, s49, 896
    v_mul_u32_u24 v6, 28, v6
    v_add_u32 v6, s53, v6
    s_lshl_b32 s53, s49, 4
    s_lshl_b32 s53, s53, 8
    s_add_u32 s53, s53, 1179648
    v_mov_b32 v228, s53
    s_mov_b32 s69, 0x07060302
    s_mul_i32 s53, s3, 57344
    v_mul_u32_u24 v5, 14336, v13
    v_lshl_add_u32 v5, v14, 4, v5
    v_add_u32 v5, s53, v5
    s_mul_i32 s81, s2, 5
    s_and_b32 s81, s81, 31
    s_lshl_b32 s81, s81, 15
    s_lshl_b32 s53, s49, 4
    s_add_u32 s53, s53, s48
    s_lshl_b32 s53, s53, 2
    s_add_u32 s53, s53, s50
    s_lshl_b32 s54, s53, 20
    s_lshl_b32 s72, s48, 9
    s_mul_i32 s71, s48, 229376
    s_mov_b32 s22, 1048576
    s_mov_b32 s23, 0x20000
    s_mov_b32 s26, 1048576
    s_mov_b32 s27, 0x20000
    s_mov_b32 s38, 3584
    s_mov_b32 s39, 0x20000
    s_mov_b32 s34, 229376
    s_mov_b32 s35, 0x20000
    s_mov_b32 s42, 4194304
    s_mov_b32 s43, 0x20000
    s_mov_b32 s46, 3584
    s_mov_b32 s47, 0x20000
    s_sub_u32 s30, 3670016, s72
    s_mov_b32 s31, 0x20000
    s_waitcnt lgkmcnt(0)
    s_mov_b32 s40, s18
    s_mov_b32 s41, s19
    s_add_u32 s20, s6, s54
    s_addc_u32 s21, s7, 0
    s_mov_b32 s36, s4
    s_mov_b32 s37, s5
    s_add_u32 s28, s10, s72
    s_addc_u32 s29, s11, 0
    s_add_u32 s24, s8, s54
    s_addc_u32 s25, s9, 0
    s_add_u32 s32, s12, s71
    s_addc_u32 s33, s13, 0
    s_mov_b32 s44, s14
    s_mov_b32 s45, s15
    buffer_load_dword v228, v228, s[40:43], 0 offen
    s_add_u32 s53, s81, 163840
    s_and_b32 s53, s53, 0xfffff
    buffer_load_dwordx4 v[92:95], v2, s[20:23], s53 offen offset:0 nt
    s_add_u32 s53, s81, 163840
    s_and_b32 s53, s53, 0xfffff
    buffer_load_dwordx4 v[96:99], v2, s[20:23], s53 offen offset:256 nt
    buffer_load_dwordx4 v[44:47], v6, s[36:39], s67 offen
    buffer_load_dwordx3 v[48:50], v6, s[36:39], s67 offen offset:16
    buffer_load_dwordx4 a[0:3], v4, s[28:31], s66 offen nt
    s_add_u32 s53, s66, 8192
    buffer_load_dwordx4 a[4:7], v4, s[28:31], s53 offen nt
    s_add_u32 s53, s66, 16384
    buffer_load_dwordx4 a[8:11], v4, s[28:31], s53 offen nt
    s_add_u32 s53, s66, 24576
    buffer_load_dwordx4 a[12:15], v4, s[28:31], s53 offen nt
    s_add_u32 s53, s66, 32768
    buffer_load_dwordx4 a[16:19], v4, s[28:31], s53 offen nt
    s_add_u32 s53, s66, 40960
    buffer_load_dwordx4 a[20:23], v4, s[28:31], s53 offen nt
    s_add_u32 s53, s66, 49152
    buffer_load_dwordx4 a[24:27], v4, s[28:31], s53 offen nt
    s_add_u32 s53, s66, 57344
    buffer_load_dwordx4 a[28:31], v4, s[28:31], s53 offen nt
    s_add_u32 s53, s66, 65536
    buffer_load_dwordx4 a[32:35], v4, s[28:31], s53 offen nt
    s_add_u32 s53, s66, 73728
    buffer_load_dwordx4 a[36:39], v4, s[28:31], s53 offen nt
    s_add_u32 s53, s66, 81920
    buffer_load_dwordx4 a[40:43], v4, s[28:31], s53 offen nt
    s_add_u32 s53, s66, 90112
    buffer_load_dwordx4 a[44:47], v4, s[28:31], s53 offen nt
    s_add_u32 s53, s66, 98304
    buffer_load_dwordx4 a[48:51], v4, s[28:31], s53 offen nt
    s_add_u32 s53, s66, 106496
    buffer_load_dwordx4 a[52:55], v4, s[28:31], s53 offen nt
    s_add_u32 s53, s28, s66
    s_bfe_u32 s53, s53, 0x30007
    s_cmp_eq_u32 s53, 3
    s_cbranch_scc1 L_qalt
    s_add_u32 s53, s81, 163840
    s_and_b32 s53, s53, 0xfffff
    buffer_load_dwordx4 v[100:103], v2, s[20:23], s53 offen offset:2048 nt
    s_add_u32 s53, s81, 163840
    s_and_b32 s53, s53, 0xfffff
    buffer_load_dwordx4 v[104:107], v2, s[20:23], s53 offen offset:2304 nt
    s_add_u32 s53, s81, 180224
    s_and_b32 s53, s53, 0xfffff
    buffer_load_dwordx4 v[108:111], v2, s[20:23], s53 offen offset:0 nt
    s_add_u32 s53, s81, 180224
    s_and_b32 s53, s53, 0xfffff
    buffer_load_dwordx4 v[112:115], v2, s[20:23], s53 offen offset:256 nt
    v_and_b32 v15, 1, v14
    v_cmp_eq_u32 vcc, 1, v15
    v_mov_b32 v11, 0x0c0c0100
    v_mov_b32 v12, 0x01000c0c
    v_cndmask_b32 v11, v11, v12, vcc
    v_mov_b32 v12, 0x0c0c0302
    v_mov_b32 v10, 0x03020c0c
    v_cndmask_b32 v12, v12, v10, vcc
    v_mov_b32 v10, 0x0000ffff
    v_mov_b32 v9, 0xffff0000
    v_cndmask_b32 v10, v10, v9, vcc
    v_lshrrev_b32 v15, 1, v14
    v_mov_b32 v9, 0x0c0c0c0c
    v_cmp_eq_u32 vcc, 0, v15
    s_nop 1
    v_cndmask_b32 v24, 0, v10, vcc
    v_cmp_eq_u32 vcc, 1, v15
    s_nop 1
    v_cndmask_b32 v25, 0, v10, vcc
    v_cmp_eq_u32 vcc, 2, v15
    s_nop 1
    v_cndmask_b32 v26, 0, v10, vcc
    v_cmp_eq_u32 vcc, 3, v15
    s_nop 1
    v_cndmask_b32 v27, 0, v10, vcc
    v_and_b32 v15, 3, v15
    v_cmp_eq_u32 vcc, 0, v15
    s_nop 1
    v_cndmask_b32 v28, v9, v11, vcc
    v_cndmask_b32 v29, v9, v12, vcc
    v_cmp_eq_u32 vcc, 1, v15
    s_nop 1
    v_cndmask_b32 v30, v9, v11, vcc
    v_cndmask_b32 v31, v9, v12, vcc
    v_cmp_eq_u32 vcc, 2, v15
    s_nop 1
    v_cndmask_b32 v32, v9, v11, vcc
    v_cndmask_b32 v33, v9, v12, vcc
    v_cmp_eq_u32 vcc, 3, v15
    s_nop 1
    v_cndmask_b32 v34, v9, v11, vcc
    v_cndmask_b32 v35, v9, v12, vcc
    v_mov_b32 v9, 0
    s_waitcnt vmcnt(19)
    v_perm_b32 v36, v44, v44, v28
    v_perm_b32 v37, v44, v44, v30
    v_perm_b32 v38, v44, v44, v32
    v_perm_b32 v39, v44, v44, v34
    s_waitcnt vmcnt(17)
    s_nop 1
    v_mfma_f32_16x16x32_bf16 v[16:19], a[0:3], v[36:39], 0
    v_perm_b32 v40, v44, v44, v29
    v_perm_b32 v41, v44, v44, v31
    v_perm_b32 v42, v44, v44, v33
    v_perm_b32 v43, v44, v44, v35
    s_waitcnt vmcnt(16)
    s_nop 1
    v_mfma_f32_16x16x32_bf16 v[20:23], a[4:7], v[40:43], 0
    v_perm_b32 v36, v45, v45, v28
    v_perm_b32 v37, v45, v45, v30
    v_perm_b32 v38, v45, v45, v32
    v_perm_b32 v39, v45, v45, v34
    s_waitcnt vmcnt(15)
    s_nop 1
    v_mfma_f32_16x16x32_bf16 v[16:19], a[8:11], v[36:39], v[16:19]
    v_perm_b32 v40, v45, v45, v29
    v_perm_b32 v41, v45, v45, v31
    v_perm_b32 v42, v45, v45, v33
    v_perm_b32 v43, v45, v45, v35
    s_waitcnt vmcnt(14)
    s_nop 1
    v_mfma_f32_16x16x32_bf16 v[20:23], a[12:15], v[40:43], v[20:23]
    v_perm_b32 v36, v46, v46, v28
    v_perm_b32 v37, v46, v46, v30
    v_perm_b32 v38, v46, v46, v32
    v_perm_b32 v39, v46, v46, v34
    s_waitcnt vmcnt(13)
    s_nop 1
    v_mfma_f32_16x16x32_bf16 v[16:19], a[16:19], v[36:39], v[16:19]
    v_perm_b32 v40, v46, v46, v29
    v_perm_b32 v41, v46, v46, v31
    v_perm_b32 v42, v46, v46, v33
    v_perm_b32 v43, v46, v46, v35
    s_waitcnt vmcnt(12)
    s_nop 1
    v_mfma_f32_16x16x32_bf16 v[20:23], a[20:23], v[40:43], v[20:23]
    v_perm_b32 v36, v47, v47, v28
    v_perm_b32 v37, v47, v47, v30
    v_perm_b32 v38, v47, v47, v32
    v_perm_b32 v39, v47, v47, v34
    s_waitcnt vmcnt(11)
    s_nop 1
    v_mfma_f32_16x16x32_bf16 v[16:19], a[24:27], v[36:39], v[16:19]
    v_perm_b32 v40, v47, v47, v29
    v_perm_b32 v41, v47, v47, v31
    v_perm_b32 v42, v47, v47, v33
    v_perm_b32 v43, v47, v47, v35
    s_waitcnt vmcnt(10)
    s_nop 1
    v_mfma_f32_16x16x32_bf16 v[20:23], a[28:31], v[40:43], v[20:23]
    v_perm_b32 v36, v48, v48, v28
    v_perm_b32 v37, v48, v48, v30
    v_perm_b32 v38, v48, v48, v32
    v_perm_b32 v39, v48, v48, v34
    s_waitcnt vmcnt(9)
    s_nop 1
    v_mfma_f32_16x16x32_bf16 v[16:19], a[32:35], v[36:39], v[16:19]
    v_perm_b32 v40, v48, v48, v29
    v_perm_b32 v41, v48, v48, v31
    v_perm_b32 v42, v48, v48, v33
    v_perm_b32 v43, v48, v48, v35
    s_waitcnt vmcnt(8)
    s_nop 1
    v_mfma_f32_16x16x32_bf16 v[20:23], a[36:39], v[40:43], v[20:23]
    v_perm_b32 v36, v49, v49, v28
    v_perm_b32 v37, v49, v49, v30
    v_perm_b32 v38, v49, v49, v32
    v_perm_b32 v39, v49, v49, v34
    s_waitcnt vmcnt(7)
    s_nop 1
    v_mfma_f32_16x16x32_bf16 v[16:19], a[40:43], v[36:39], v[16:19]
    v_perm_b32 v40, v49, v49, v29
    v_perm_b32 v41, v49, v49, v31
    v_perm_b32 v42, v49, v49, v33
    v_perm_b32 v43, v49, v49, v35
    s_waitcnt vmcnt(6)
    s_nop 1
    v_mfma_f32_16x16x32_bf16 v[20:23], a[44:47], v[40:43], v[20:23]
    v_perm_b32 v36, v50, v50, v28
    v_perm_b32 v37, v50, v50, v30
    v_perm_b32 v38, v50, v50, v32
    v_perm_b32 v39, v50, v50, v34
    s_waitcnt vmcnt(5)
    s_nop 1
    v_mfma_f32_16x16x32_bf16 v[16:19], a[48:51], v[36:39], v[16:19]
    v_perm_b32 v40, v50, v50, v29
    v_perm_b32 v41, v50, v50, v31
    v_perm_b32 v42, v50, v50, v33
    v_perm_b32 v43, v50, v50, v35
    s_waitcnt vmcnt(4)
    s_nop 1
    v_mfma_f32_16x16x32_bf16 v[20:23], a[52:55], v[40:43], v[20:23]
    v_lshrrev_b32 v13, 4, v1
    v_lshlrev_b32 v13, 7, v13
    v_and_b32 v15, 7, v1
    v_lshl_add_u32 v13, v15, 2, v13
    s_lshl_b32 s53, s3, 9
    v_add_u32 v220, s53, v13
    v_readfirstlane_b32 s68, v228
    s_nop 4
    v_add_f32 v16, v16, v20
    v_add_f32 v17, v17, v21
    v_add_f32 v18, v18, v22
    v_add_f32 v19, v19, v23
    s_mov_b32 exec_lo, 0x00ff00ff
    s_mov_b32 exec_hi, 0xff00ff00
    ds_write_b32 v220, v16 offset:0
    ds_write_b32 v220, v17 offset:32
    ds_write_b32 v220, v18 offset:64
    ds_write_b32 v220, v19 offset:96
    s_mov_b64 exec, -1
    s_add_u32 s73, s68, 1
    s_and_b32 s68, s73, 0xffff
    s_and_b32 s74, s73, 0xff
    s_add_u32 s53, s81, 180224
    s_and_b32 s53, s53, 0xfffff
    buffer_load_dwordx4 v[116:119], v2, s[20:23], s53 offen offset:2048 nt
    s_add_u32 s53, s81, 180224
    s_and_b32 s53, s53, 0xfffff
    buffer_load_dwordx4 v[120:123], v2, s[20:23], s53 offen offset:2304 nt
    s_waitcnt lgkmcnt(0)
    s_barrier
    s_cmp_lg_u32 s3, 0
    s_cbranch_scc1 L_qpub1
    v_lshlrev_b32 v13, 2, v1
    ds_read_b32 v60, v13 offset:0
    ds_read_b32 v61, v13 offset:256
    ds_read_b32 v62, v13 offset:512
    ds_read_b32 v63, v13 offset:768
    ds_read_b32 v64, v13 offset:1024
    ds_read_b32 v65, v13 offset:1280
    ds_read_b32 v66, v13 offset:1536
    ds_read_b32 v67, v13 offset:1792
    s_lshl_b32 s53, s49, 4
    s_add_u32 s53, s53, s48
    s_lshl_b32 s53, s53, 10
    s_lshl_b32 s72, s50, 8
    s_add_u32 s53, s53, s72
    s_add_u32 s53, s53, 1048576
    s_waitcnt lgkmcnt(0)
    v_add_f32 v60, v60, v61
    v_add_f32 v62, v62, v63
    v_add_f32 v64, v64, v65
    v_add_f32 v66, v66, v67
    v_add_f32 v60, v60, v62
    v_add_f32 v64, v64, v66
    v_add_f32 v60, v60, v64
    v_cvt_pk_bf16_f32 v60, v60, v60
    v_lshlrev_b32 v60, 16, v60
    v_or_b32 v60, s68, v60
    buffer_store_dword v60, v13, s[40:43], s53 offen sc1
L_qpub1:
    v_lshrrev_b32 v14, 4, v1
    v_lshlrev_b32 v14, 7, v14
    v_and_b32 v15, 3, v1
    v_lshl_add_u32 v14, v15, 5, v14
    s_lshl_b32 s53, s49, 4
    s_add_u32 s53, s53, s48
    s_lshl_b32 s53, s53, 10
    s_add_u32 s53, s53, 1048576
    v_add_u32 v14, s53, v14
    s_waitcnt vmcnt(5)
    s_add_u32 s53, s81, 0
    s_and_b32 s53, s53, 0xfffff
    buffer_load_dwordx4 v[124:127], v2, s[20:23], s53 offen offset:0 nt
    s_waitcnt vmcnt(5)
    s_add_u32 s53, s81, 0
    s_and_b32 s53, s53, 0xfffff
    buffer_load_dwordx4 v[128:131], v2, s[20:23], s53 offen offset:256 nt
    s_waitcnt vmcnt(5)
    s_add_u32 s53, s81, 0
    s_and_b32 s53, s53, 0xfffff
    buffer_load_dwordx4 v[132:135], v2, s[20:23], s53 offen offset:2048 nt
    s_waitcnt vmcnt(5)
    s_add_u32 s53, s81, 0
    s_and_b32 s53, s53, 0xfffff
    buffer_load_dwordx4 v[136:139], v2, s[20:23], s53 offen offset:2304 nt
    s_waitcnt vmcnt(5)
    s_add_u32 s53, s81, 16384
    s_and_b32 s53, s53, 0xfffff
    buffer_load_dwordx4 v[140:143], v2, s[20:23], s53 offen offset:0 nt
    s_waitcnt vmcnt(5)
    s_add_u32 s53, s81, 16384
    s_and_b32 s53, s53, 0xfffff
    buffer_load_dwordx4 v[144:147], v2, s[20:23], s53 offen offset:256 nt
    s_waitcnt vmcnt(5)
    s_add_u32 s53, s81, 16384
    s_and_b32 s53, s53, 0xfffff
    buffer_load_dwordx4 v[148:151], v2, s[20:23], s53 offen offset:2048 nt
    s_waitcnt vmcnt(5)
    s_add_u32 s53, s81, 16384
    s_and_b32 s53, s53, 0xfffff
    buffer_load_dwordx4 v[152:155], v2, s[20:23], s53 offen offset:2304 nt
    s_waitcnt vmcnt(5)
    s_add_u32 s53, s81, 32768
    s_and_b32 s53, s53, 0xfffff
    buffer_load_dwordx4 v[156:159], v2, s[20:23], s53 offen offset:0 nt
    s_waitcnt vmcnt(5)
    s_add_u32 s53, s81, 32768
    s_and_b32 s53, s53, 0xfffff
    buffer_load_dwordx4 v[160:163], v2, s[20:23], s53 offen offset:256 nt
    s_waitcnt vmcnt(5)
    s_add_u32 s53, s81, 32768
    s_and_b32 s53, s53, 0xfffff
    buffer_load_dwordx4 v[164:167], v2, s[20:23], s53 offen offset:2048 nt
    s_waitcnt vmcnt(5)
    s_add_u32 s53, s81, 32768
    s_and_b32 s53, s53, 0xfffff
    buffer_load_dwordx4 v[168:171], v2, s[20:23], s53 offen offset:2304 nt
    s_waitcnt vmcnt(5)
    s_add_u32 s53, s81, 49152
    s_and_b32 s53, s53, 0xfffff
    buffer_load_dwordx4 v[172:175], v2, s[20:23], s53 offen offset:0 nt
    s_waitcnt vmcnt(5)
    s_add_u32 s53, s81, 49152
    s_and_b32 s53, s53, 0xfffff
    buffer_load_dwordx4 v[176:179], v2, s[20:23], s53 offen offset:256 nt
    s_waitcnt vmcnt(5)
    s_add_u32 s53, s81, 49152
    s_and_b32 s53, s53, 0xfffff
    buffer_load_dwordx4 v[180:183], v2, s[20:23], s53 offen offset:2048 nt
    s_waitcnt vmcnt(5)
    s_add_u32 s53, s81, 49152
    s_and_b32 s53, s53, 0xfffff
    buffer_load_dwordx4 v[184:187], v2, s[20:23], s53 offen offset:2304 nt
    s_waitcnt vmcnt(5)
    s_add_u32 s53, s81, 65536
    s_and_b32 s53, s53, 0xfffff
    buffer_load_dwordx4 v[188:191], v2, s[20:23], s53 offen offset:0 nt
    s_waitcnt vmcnt(5)
    s_add_u32 s53, s81, 65536
    s_and_b32 s53, s53, 0xfffff
    buffer_load_dwordx4 v[192:195], v2, s[20:23], s53 offen offset:256 nt
    s_waitcnt vmcnt(5)
    s_add_u32 s53, s81, 65536
    s_and_b32 s53, s53, 0xfffff
    buffer_load_dwordx4 v[196:199], v2, s[20:23], s53 offen offset:2048 nt
    s_waitcnt vmcnt(5)
    s_add_u32 s53, s81, 65536
    s_and_b32 s53, s53, 0xfffff
    buffer_load_dwordx4 v[200:203], v2, s[20:23], s53 offen offset:2304 nt
    buffer_load_dwordx4 v[60:63], v14, s[40:43], 0 offen offset:0 sc1
    buffer_load_dwordx4 v[64:67], v14, s[40:43], 0 offen offset:16 sc1
    buffer_load_dwordx4 v[68:71], v14, s[40:43], 0 offen offset:512 sc1
    buffer_load_dwordx4 v[72:75], v14, s[40:43], 0 offen offset:528 sc1
    s_waitcnt vmcnt(9)
    s_add_u32 s53, s81, 81920
    s_and_b32 s53, s53, 0xfffff
    buffer_load_dwordx4 v[204:207], v2, s[20:23], s53 offen offset:0 nt
    s_waitcnt vmcnt(9)
    s_add_u32 s53, s81, 81920
    s_and_b32 s53, s53, 0xfffff
    buffer_load_dwordx4 v[208:211], v2, s[20:23], s53 offen offset:256 nt
    s_waitcnt vmcnt(9)
    s_add_u32 s53, s81, 81920
    s_and_b32 s53, s53, 0xfffff
    buffer_load_dwordx4 v[212:215], v2, s[20:23], s53 offen offset:2048 nt
    s_waitcnt vmcnt(9)
    s_add_u32 s53, s81, 81920
    s_and_b32 s53, s53, 0xfffff
    buffer_load_dwordx4 v[216:219], v2, s[20:23], s53 offen offset:2304 nt
    s_waitcnt vmcnt(9)
    s_add_u32 s53, s81, 98304
    s_and_b32 s53, s53, 0xfffff
    buffer_load_dwordx4 a[192:195], v2, s[20:23], s53 offen offset:0 nt
    s_waitcnt vmcnt(9)
    s_add_u32 s53, s81, 98304
    s_and_b32 s53, s53, 0xfffff
    buffer_load_dwordx4 a[196:199], v2, s[20:23], s53 offen offset:256 nt
    s_waitcnt vmcnt(6)
    v_xor_b32 v11, s68, v60
    v_xor_b32 v12, s68, v61
    v_xor_b32 v10, s68, v62
    v_or3_b32 v11, v11, v12, v10
    v_xor_b32 v12, s68, v63
    v_xor_b32 v10, s68, v64
    v_or3_b32 v11, v11, v12, v10
    v_xor_b32 v12, s68, v65
    v_xor_b32 v10, s68, v66
    v_or3_b32 v11, v11, v12, v10
    v_xor_b32 v12, s68, v67
    v_xor_b32 v10, s68, v68
    v_or3_b32 v11, v11, v12, v10
    v_xor_b32 v12, s68, v69
    v_xor_b32 v10, s68, v70
    v_or3_b32 v11, v11, v12, v10
    v_xor_b32 v12, s68, v71
    v_xor_b32 v10, s68, v72
    v_or3_b32 v11, v11, v12, v10
    v_xor_b32 v12, s68, v73
    v_xor_b32 v10, s68, v74
    v_or3_b32 v11, v11, v12, v10
    v_xor_b32 v12, s68, v75
    v_or_b32 v11, v11, v12
    v_and_b32 v11, 0xffff, v11
    v_cmp_ne_u32 vcc, 0, v11
    s_nop 4
    s_cbranch_vccnz L_qslow
L_qpack:
    v_perm_b32 v220, v61, v60, s69
    v_perm_b32 v221, v63, v62, s69
    v_perm_b32 v222, v65, v64, s69
    v_perm_b32 v223, v67, v66, s69
    v_perm_b32 v224, v69, v68, s69
    v_perm_b32 v225, v71, v70, s69
    v_perm_b32 v226, v73, v72, s69
    v_perm_b32 v227, v75, v74, s69
L_qready:
    s_waitcnt vmcnt(5)
    s_add_u32 s53, s81, 98304
    s_and_b32 s53, s53, 0xfffff
    buffer_load_dwordx4 a[200:203], v2, s[20:23], s53 offen offset:2048 nt
    s_waitcnt vmcnt(5)
    s_add_u32 s53, s81, 98304
    s_and_b32 s53, s53, 0xfffff
    buffer_load_dwordx4 a[204:207], v2, s[20:23], s53 offen offset:2304 nt
    s_waitcnt vmcnt(5)
    s_add_u32 s53, s81, 114688
    s_and_b32 s53, s53, 0xfffff
    buffer_load_dwordx4 a[208:211], v2, s[20:23], s53 offen offset:0 nt
    s_waitcnt vmcnt(5)
    s_add_u32 s53, s81, 114688
    s_and_b32 s53, s53, 0xfffff
    buffer_load_dwordx4 a[212:215], v2, s[20:23], s53 offen offset:256 nt
    s_waitcnt vmcnt(5)
    s_add_u32 s53, s81, 114688
    s_and_b32 s53, s53, 0xfffff
    buffer_load_dwordx4 a[216:219], v2, s[20:23], s53 offen offset:2048 nt
    s_waitcnt vmcnt(5)
    s_add_u32 s53, s81, 114688
    s_and_b32 s53, s53, 0xfffff
    buffer_load_dwordx4 a[220:223], v2, s[20:23], s53 offen offset:2304 nt
    s_waitcnt vmcnt(5)
    s_add_u32 s53, s81, 131072
    s_and_b32 s53, s53, 0xfffff
    buffer_load_dwordx4 a[224:227], v2, s[20:23], s53 offen offset:0 nt
    s_waitcnt vmcnt(5)
    s_add_u32 s53, s81, 131072
    s_and_b32 s53, s53, 0xfffff
    buffer_load_dwordx4 a[228:231], v2, s[20:23], s53 offen offset:256 nt
    s_waitcnt vmcnt(5)
    s_add_u32 s53, s81, 131072
    s_and_b32 s53, s53, 0xfffff
    buffer_load_dwordx4 a[232:235], v2, s[20:23], s53 offen offset:2048 nt
    s_waitcnt vmcnt(5)
    s_add_u32 s53, s81, 131072
    s_and_b32 s53, s53, 0xfffff
    buffer_load_dwordx4 a[236:239], v2, s[20:23], s53 offen offset:2304 nt
    s_waitcnt vmcnt(5)
    s_add_u32 s53, s81, 147456
    s_and_b32 s53, s53, 0xfffff
    buffer_load_dwordx4 a[240:243], v2, s[20:23], s53 offen offset:0 nt
    s_waitcnt vmcnt(5)
    s_add_u32 s53, s81, 147456
    s_and_b32 s53, s53, 0xfffff
    buffer_load_dwordx4 a[244:247], v2, s[20:23], s53 offen offset:256 nt
    s_waitcnt vmcnt(5)
    s_add_u32 s53, s81, 147456
    s_and_b32 s53, s53, 0xfffff
    buffer_load_dwordx4 a[248:251], v2, s[20:23], s53 offen offset:2048 nt
    s_waitcnt vmcnt(5)
    s_add_u32 s53, s81, 147456
    s_and_b32 s53, s53, 0xfffff
    buffer_load_dwordx4 a[252:255], v2, s[20:23], s53 offen offset:2304 nt
L_qmerge:
    s_mov_b32 s56, 0xf000f
    s_mov_b32 s57, 0xf000f
    s_mov_b32 s58, 0xf000f0
    s_mov_b32 s59, 0xf000f0
    s_mov_b32 s60, 0xf000f00
    s_mov_b32 s61, 0xf000f00
    s_mov_b32 s62, 0xf000f000
    s_mov_b32 s63, 0xf000f000
    s_lshl_b32 s53, s3, 13
    s_add_u32 s53, s53, 16384
    v_lshlrev_b32 v7, 2, v1
    v_add_u32 v7, s53, v7
    v_mov_b32 v8, 0xff800000
    s_waitcnt lgkmcnt(0)
    v_cndmask_b32 v60, 0, v220, s[56:57]
    v_cndmask_b32 v61, 0, v221, s[56:57]
    v_cndmask_b32 v62, 0, v222, s[56:57]
    v_cndmask_b32 v63, 0, v223, s[56:57]
    v_cndmask_b32 v64, 0, v224, s[56:57]
    v_cndmask_b32 v65, 0, v225, s[56:57]
    v_cndmask_b32 v66, 0, v226, s[56:57]
    v_cndmask_b32 v67, 0, v227, s[56:57]
    v_cndmask_b32 v68, 0, v220, s[58:59]
    v_cndmask_b32 v69, 0, v221, s[58:59]
    v_cndmask_b32 v70, 0, v222, s[58:59]
    v_cndmask_b32 v71, 0, v223, s[58:59]
    v_cndmask_b32 v72, 0, v224, s[58:59]
    v_cndmask_b32 v73, 0, v225, s[58:59]
    v_cndmask_b32 v74, 0, v226, s[58:59]
    v_cndmask_b32 v75, 0, v227, s[58:59]
    v_cndmask_b32 v76, 0, v220, s[60:61]
    v_cndmask_b32 v77, 0, v221, s[60:61]
    v_cndmask_b32 v78, 0, v222, s[60:61]
    v_cndmask_b32 v79, 0, v223, s[60:61]
    v_cndmask_b32 v80, 0, v224, s[60:61]
    v_cndmask_b32 v81, 0, v225, s[60:61]
    v_cndmask_b32 v82, 0, v226, s[60:61]
    v_cndmask_b32 v83, 0, v227, s[60:61]
    v_cndmask_b32 v84, 0, v220, s[62:63]
    v_cndmask_b32 v85, 0, v221, s[62:63]
    v_cndmask_b32 v86, 0, v222, s[62:63]
    v_cndmask_b32 v87, 0, v223, s[62:63]
    v_cndmask_b32 v88, 0, v224, s[62:63]
    v_cndmask_b32 v89, 0, v225, s[62:63]
    v_cndmask_b32 v90, 0, v226, s[62:63]
    v_cndmask_b32 v91, 0, v227, s[62:63]
    s_nop 1
    s_add_u32 s52, s81, 163840
    s_and_b32 s52, s52, 0xfffff
    s_add_u32 s80, s52, 32768
    s_and_b32 s80, s80, 0xfffff
    v_mov_b32 v12, v7
    v_mfma_f32_16x16x32_bf16 v[16:19], v[92:95], v[60:63], 0
    v_mfma_f32_16x16x32_bf16 v[16:19], v[96:99], v[64:67], v[16:19]
    v_mfma_f32_16x16x32_bf16 v[16:19], v[100:103], v[68:71], v[16:19]
    buffer_load_dwordx4 v[92:95], v2, s[20:23], s80 offen offset:0 nt
    v_mfma_f32_16x16x32_bf16 v[16:19], v[104:107], v[72:75], v[16:19]
    buffer_load_dwordx4 v[96:99], v2, s[20:23], s80 offen offset:256 nt
    v_mfma_f32_16x16x32_bf16 v[16:19], v[108:111], v[76:79], v[16:19]
    v_mfma_f32_16x16x32_bf16 v[16:19], v[112:115], v[80:83], v[16:19]
    buffer_load_dwordx4 v[100:103], v2, s[20:23], s80 offen offset:2048 nt
    v_mfma_f32_16x16x32_bf16 v[16:19], v[116:119], v[84:87], v[16:19]
    buffer_load_dwordx4 v[104:107], v2, s[20:23], s80 offen offset:2304 nt
    v_mfma_f32_16x16x32_bf16 v[16:19], v[120:123], v[88:91], v[16:19]
    s_add_u32 s53, s80, 16384
    buffer_load_dwordx4 v[108:111], v2, s[20:23], s53 offen offset:0 nt
    s_nop 7
    v_mov_b32_dpp v13, v16 quad_perm:[0,0,0,0] row_mask:0xf bank_mask:0xf
    v_mov_b32_dpp v14, v18 quad_perm:[2,2,2,2] row_mask:0xf bank_mask:0xf
    s_nop 0
    v_add_f32_dpp v13, v17, v13 quad_perm:[1,1,1,1] row_mask:0xf bank_mask:0xf
    v_add_f32_dpp v14, v19, v14 quad_perm:[3,3,3,3] row_mask:0xf bank_mask:0xf
    v_add_f32 v13, v13, v14
    ds_write_b32 v7, v13 offset:1280
    v_max_f32 v8, v8, v13
    s_mov_b32 s52, s80
    s_add_u32 s80, s80, 32768
    s_and_b32 s80, s80, 0xfffff
    v_mfma_f32_16x16x32_bf16 v[16:19], v[124:127], v[60:63], 0
    v_mfma_f32_16x16x32_bf16 v[16:19], v[128:131], v[64:67], v[16:19]
    v_mfma_f32_16x16x32_bf16 v[16:19], v[132:135], v[68:71], v[16:19]
    v_mfma_f32_16x16x32_bf16 v[16:19], v[136:139], v[72:75], v[16:19]
    v_mfma_f32_16x16x32_bf16 v[16:19], v[140:143], v[76:79], v[16:19]
    v_mfma_f32_16x16x32_bf16 v[16:19], v[144:147], v[80:83], v[16:19]
    v_mfma_f32_16x16x32_bf16 v[16:19], v[148:151], v[84:87], v[16:19]
    v_mfma_f32_16x16x32_bf16 v[16:19], v[152:155], v[88:91], v[16:19]
    s_nop 7
    v_mov_b32_dpp v13, v16 quad_perm:[0,0,0,0] row_mask:0xf bank_mask:0xf
    v_mov_b32_dpp v14, v18 quad_perm:[2,2,2,2] row_mask:0xf bank_mask:0xf
    s_nop 0
    v_add_f32_dpp v13, v17, v13 quad_perm:[1,1,1,1] row_mask:0xf bank_mask:0xf
    v_add_f32_dpp v14, v19, v14 quad_perm:[3,3,3,3] row_mask:0xf bank_mask:0xf
    v_add_f32 v13, v13, v14
    ds_write_b32 v7, v13 offset:0
    v_max_f32 v8, v8, v13
    v_mfma_f32_16x16x32_bf16 v[16:19], v[156:159], v[60:63], 0
    v_mfma_f32_16x16x32_bf16 v[16:19], v[160:163], v[64:67], v[16:19]
    v_mfma_f32_16x16x32_bf16 v[16:19], v[164:167], v[68:71], v[16:19]
    v_mfma_f32_16x16x32_bf16 v[16:19], v[168:171], v[72:75], v[16:19]
    v_mfma_f32_16x16x32_bf16 v[16:19], v[172:175], v[76:79], v[16:19]
    v_mfma_f32_16x16x32_bf16 v[16:19], v[176:179], v[80:83], v[16:19]
    v_mfma_f32_16x16x32_bf16 v[16:19], v[180:183], v[84:87], v[16:19]
    v_mfma_f32_16x16x32_bf16 v[16:19], v[184:187], v[88:91], v[16:19]
    s_nop 7
    v_mov_b32_dpp v13, v16 quad_perm:[0,0,0,0] row_mask:0xf bank_mask:0xf
    v_mov_b32_dpp v14, v18 quad_perm:[2,2,2,2] row_mask:0xf bank_mask:0xf
    s_nop 0
    v_add_f32_dpp v13, v17, v13 quad_perm:[1,1,1,1] row_mask:0xf bank_mask:0xf
    v_add_f32_dpp v14, v19, v14 quad_perm:[3,3,3,3] row_mask:0xf bank_mask:0xf
    v_add_f32 v13, v13, v14
    ds_write_b32 v7, v13 offset:256
    v_max_f32 v8, v8, v13
    v_mfma_f32_16x16x32_bf16 v[16:19], v[188:191], v[60:63], 0
    v_mfma_f32_16x16x32_bf16 v[16:19], v[192:195], v[64:67], v[16:19]
    v_mfma_f32_16x16x32_bf16 v[16:19], v[196:199], v[68:71], v[16:19]
    v_mfma_f32_16x16x32_bf16 v[16:19], v[200:203], v[72:75], v[16:19]
    v_mfma_f32_16x16x32_bf16 v[16:19], v[204:207], v[76:79], v[16:19]
    v_mfma_f32_16x16x32_bf16 v[16:19], v[208:211], v[80:83], v[16:19]
    v_mfma_f32_16x16x32_bf16 v[16:19], v[212:215], v[84:87], v[16:19]
    v_mfma_f32_16x16x32_bf16 v[16:19], v[216:219], v[88:91], v[16:19]
    s_nop 7
    v_mov_b32_dpp v13, v16 quad_perm:[0,0,0,0] row_mask:0xf bank_mask:0xf
    v_mov_b32_dpp v14, v18 quad_perm:[2,2,2,2] row_mask:0xf bank_mask:0xf
    s_nop 0
    v_add_f32_dpp v13, v17, v13 quad_perm:[1,1,1,1] row_mask:0xf bank_mask:0xf
    v_add_f32_dpp v14, v19, v14 quad_perm:[3,3,3,3] row_mask:0xf bank_mask:0xf
    v_add_f32 v13, v13, v14
    ds_write_b32 v7, v13 offset:512
    v_max_f32 v8, v8, v13
    v_mfma_f32_16x16x32_bf16 v[16:19], a[192:195], v[60:63], 0
    v_mfma_f32_16x16x32_bf16 v[16:19], a[196:199], v[64:67], v[16:19]
    v_mfma_f32_16x16x32_bf16 v[16:19], a[200:203], v[68:71], v[16:19]
    v_mfma_f32_16x16x32_bf16 v[16:19], a[204:207], v[72:75], v[16:19]
    v_mfma_f32_16x16x32_bf16 v[16:19], a[208:211], v[76:79], v[16:19]
    v_mfma_f32_16x16x32_bf16 v[16:19], a[212:215], v[80:83], v[16:19]
    v_mfma_f32_16x16x32_bf16 v[16:19], a[216:219], v[84:87], v[16:19]
    s_waitcnt vmcnt(13)
    v_mfma_f32_16x16x32_bf16 v[16:19], a[220:223], v[88:91], v[16:19]
    s_nop 7
    v_mov_b32_dpp v13, v16 quad_perm:[0,0,0,0] row_mask:0xf bank_mask:0xf
    v_mov_b32_dpp v14, v18 quad_perm:[2,2,2,2] row_mask:0xf bank_mask:0xf
    s_nop 0
    v_add_f32_dpp v13, v17, v13 quad_perm:[1,1,1,1] row_mask:0xf bank_mask:0xf
    v_add_f32_dpp v14, v19, v14 quad_perm:[3,3,3,3] row_mask:0xf bank_mask:0xf
    v_add_f32 v13, v13, v14
    ds_write_b32 v7, v13 offset:768
    v_max_f32 v8, v8, v13
    s_waitcnt vmcnt(12)
    v_mfma_f32_16x16x32_bf16 v[16:19], a[224:227], v[60:63], 0
    s_waitcnt vmcnt(11)
    v_mfma_f32_16x16x32_bf16 v[16:19], a[228:231], v[64:67], v[16:19]
    s_waitcnt vmcnt(10)
    v_mfma_f32_16x16x32_bf16 v[16:19], a[232:235], v[68:71], v[16:19]
    s_waitcnt vmcnt(9)
    v_mfma_f32_16x16x32_bf16 v[16:19], a[236:239], v[72:75], v[16:19]
    s_waitcnt vmcnt(8)
    v_mfma_f32_16x16x32_bf16 v[16:19], a[240:243], v[76:79], v[16:19]
    s_waitcnt vmcnt(7)
    v_mfma_f32_16x16x32_bf16 v[16:19], a[244:247], v[80:83], v[16:19]
    s_waitcnt vmcnt(6)
    v_mfma_f32_16x16x32_bf16 v[16:19], a[248:251], v[84:87], v[16:19]
    s_waitcnt vmcnt(5)
    v_mfma_f32_16x16x32_bf16 v[16:19], a[252:255], v[88:91], v[16:19]
    s_nop 7
    v_mov_b32_dpp v13, v16 quad_perm:[0,0,0,0] row_mask:0xf bank_mask:0xf
    v_mov_b32_dpp v14, v18 quad_perm:[2,2,2,2] row_mask:0xf bank_mask:0xf
    s_nop 0
    v_add_f32_dpp v13, v17, v13 quad_perm:[1,1,1,1] row_mask:0xf bank_mask:0xf
    v_add_f32_dpp v14, v19, v14 quad_perm:[3,3,3,3] row_mask:0xf bank_mask:0xf
    v_add_f32 v13, v13, v14
    ds_write_b32 v7, v13 offset:1024
    v_max_f32 v8, v8, v13
    s_waitcnt vmcnt(4)
    v_mfma_f32_16x16x32_bf16 v[16:19], v[92:95], v[60:63], 0
    s_add_u32 s53, s52, 16384
    buffer_load_dwordx4 v[112:115], v2, s[20:23], s53 offen offset:256 nt
    s_add_u32 s53, s52, 16384
    buffer_load_dwordx4 v[116:119], v2, s[20:23], s53 offen offset:2048 nt
    s_waitcnt vmcnt(5)
    v_mfma_f32_16x16x32_bf16 v[16:19], v[96:99], v[64:67], v[16:19]
    s_add_u32 s53, s52, 16384
    buffer_load_dwordx4 v[120:123], v2, s[20:23], s53 offen offset:2304 nt
    s_add_u32 s53, s76, 0
    s_and_b32 s53, s53, 15
    s_mul_i32 s53, s53, 896
    buffer_load_dwordx4 a[0:3], v5, s[32:35], s53 offen offset:0
    s_waitcnt vmcnt(6)
    v_mfma_f32_16x16x32_bf16 v[16:19], v[100:103], v[68:71], v[16:19]
    buffer_load_dwordx4 v[92:95], v2, s[20:23], s80 offen offset:0 nt
    s_waitcnt vmcnt(6)
    v_mfma_f32_16x16x32_bf16 v[16:19], v[104:107], v[72:75], v[16:19]
    buffer_load_dwordx4 v[96:99], v2, s[20:23], s80 offen offset:256 nt
    s_waitcnt vmcnt(6)
    v_mfma_f32_16x16x32_bf16 v[16:19], v[108:111], v[76:79], v[16:19]
    s_add_u32 s53, s76, 0
    s_and_b32 s53, s53, 15
    s_mul_i32 s53, s53, 896
    buffer_load_dwordx4 a[4:7], v5, s[32:35], s53 offen offset:224
    s_waitcnt vmcnt(6)
    v_mfma_f32_16x16x32_bf16 v[16:19], v[112:115], v[80:83], v[16:19]
    buffer_load_dwordx4 v[100:103], v2, s[20:23], s80 offen offset:2048 nt
    s_waitcnt vmcnt(6)
    v_mfma_f32_16x16x32_bf16 v[16:19], v[116:119], v[84:87], v[16:19]
    buffer_load_dwordx4 v[104:107], v2, s[20:23], s80 offen offset:2304 nt
    s_add_u32 s53, s76, 0
    s_and_b32 s53, s53, 15
    s_mul_i32 s53, s53, 896
    buffer_load_dwordx4 a[8:11], v5, s[32:35], s53 offen offset:448
    s_waitcnt vmcnt(7)
    v_mfma_f32_16x16x32_bf16 v[16:19], v[120:123], v[88:91], v[16:19]
    s_add_u32 s53, s80, 16384
    buffer_load_dwordx4 v[108:111], v2, s[20:23], s53 offen offset:0 nt
    s_nop 7
    v_mov_b32_dpp v13, v16 quad_perm:[0,0,0,0] row_mask:0xf bank_mask:0xf
    v_mov_b32_dpp v14, v18 quad_perm:[2,2,2,2] row_mask:0xf bank_mask:0xf
    s_nop 0
    v_add_f32_dpp v13, v17, v13 quad_perm:[1,1,1,1] row_mask:0xf bank_mask:0xf
    v_add_f32_dpp v14, v19, v14 quad_perm:[3,3,3,3] row_mask:0xf bank_mask:0xf
    v_add_f32 v13, v13, v14
    ds_write_b32 v7, v13 offset:1536
    v_max_f32 v8, v8, v13
    s_mov_b32 s52, s80
    s_add_u32 s80, s80, 32768
    s_and_b32 s80, s80, 0xfffff
    s_waitcnt vmcnt(6)
    v_mfma_f32_16x16x32_bf16 v[16:19], v[92:95], v[60:63], 0
    s_add_u32 s53, s52, 16384
    buffer_load_dwordx4 v[112:115], v2, s[20:23], s53 offen offset:256 nt
    s_add_u32 s53, s52, 16384
    buffer_load_dwordx4 v[116:119], v2, s[20:23], s53 offen offset:2048 nt
    s_waitcnt vmcnt(7)
    v_mfma_f32_16x16x32_bf16 v[16:19], v[96:99], v[64:67], v[16:19]
    s_add_u32 s53, s52, 16384
    buffer_load_dwordx4 v[120:123], v2, s[20:23], s53 offen offset:2304 nt
    s_add_u32 s53, s76, 0
    s_and_b32 s53, s53, 15
    s_mul_i32 s53, s53, 896
    buffer_load_dwordx4 a[12:15], v5, s[32:35], s53 offen offset:672
    s_waitcnt vmcnt(7)
    v_mfma_f32_16x16x32_bf16 v[16:19], v[100:103], v[68:71], v[16:19]
    buffer_load_dwordx4 v[92:95], v2, s[20:23], s80 offen offset:0 nt
    s_waitcnt vmcnt(7)
    v_mfma_f32_16x16x32_bf16 v[16:19], v[104:107], v[72:75], v[16:19]
    buffer_load_dwordx4 v[96:99], v2, s[20:23], s80 offen offset:256 nt
    s_waitcnt vmcnt(6)
    v_mfma_f32_16x16x32_bf16 v[16:19], v[108:111], v[76:79], v[16:19]
    s_add_u32 s53, s76, 1
    s_and_b32 s53, s53, 15
    s_mul_i32 s53, s53, 896
    buffer_load_dwordx4 a[16:19], v5, s[32:35], s53 offen offset:0
    s_waitcnt vmcnt(6)
    v_mfma_f32_16x16x32_bf16 v[16:19], v[112:115], v[80:83], v[16:19]
    buffer_load_dwordx4 v[100:103], v2, s[20:23], s80 offen offset:2048 nt
    s_waitcnt vmcnt(6)
    v_mfma_f32_16x16x32_bf16 v[16:19], v[116:119], v[84:87], v[16:19]
    buffer_load_dwordx4 v[104:107], v2, s[20:23], s80 offen offset:2304 nt
    s_add_u32 s53, s76, 1
    s_and_b32 s53, s53, 15
    s_mul_i32 s53, s53, 896
    buffer_load_dwordx4 a[20:23], v5, s[32:35], s53 offen offset:224
    s_waitcnt vmcnt(7)
    v_mfma_f32_16x16x32_bf16 v[16:19], v[120:123], v[88:91], v[16:19]
    s_add_u32 s53, s80, 16384
    buffer_load_dwordx4 v[108:111], v2, s[20:23], s53 offen offset:0 nt
    s_nop 7
    v_mov_b32_dpp v13, v16 quad_perm:[0,0,0,0] row_mask:0xf bank_mask:0xf
    v_mov_b32_dpp v14, v18 quad_perm:[2,2,2,2] row_mask:0xf bank_mask:0xf
    s_nop 0
    v_add_f32_dpp v13, v17, v13 quad_perm:[1,1,1,1] row_mask:0xf bank_mask:0xf
    v_add_f32_dpp v14, v19, v14 quad_perm:[3,3,3,3] row_mask:0xf bank_mask:0xf
    v_add_f32 v13, v13, v14
    ds_write_b32 v7, v13 offset:1792
    v_max_f32 v8, v8, v13
    s_mov_b32 s52, s80
    s_add_u32 s80, s80, 32768
    s_and_b32 s80, s80, 0xfffff
    s_waitcnt vmcnt(6)
    v_mfma_f32_16x16x32_bf16 v[16:19], v[92:95], v[60:63], 0
    s_add_u32 s53, s52, 16384
    buffer_load_dwordx4 v[112:115], v2, s[20:23], s53 offen offset:256 nt
    s_add_u32 s53, s52, 16384
    buffer_load_dwordx4 v[116:119], v2, s[20:23], s53 offen offset:2048 nt
    s_waitcnt vmcnt(7)
    v_mfma_f32_16x16x32_bf16 v[16:19], v[96:99], v[64:67], v[16:19]
    s_add_u32 s53, s52, 16384
    buffer_load_dwordx4 v[120:123], v2, s[20:23], s53 offen offset:2304 nt
    s_add_u32 s53, s76, 1
    s_and_b32 s53, s53, 15
    s_mul_i32 s53, s53, 896
    buffer_load_dwordx4 a[24:27], v5, s[32:35], s53 offen offset:448
    s_waitcnt vmcnt(7)
    v_mfma_f32_16x16x32_bf16 v[16:19], v[100:103], v[68:71], v[16:19]
    buffer_load_dwordx4 v[92:95], v2, s[20:23], s80 offen offset:0 nt
    s_waitcnt vmcnt(7)
    v_mfma_f32_16x16x32_bf16 v[16:19], v[104:107], v[72:75], v[16:19]
    buffer_load_dwordx4 v[96:99], v2, s[20:23], s80 offen offset:256 nt
    s_waitcnt vmcnt(6)
    v_mfma_f32_16x16x32_bf16 v[16:19], v[108:111], v[76:79], v[16:19]
    s_add_u32 s53, s76, 1
    s_and_b32 s53, s53, 15
    s_mul_i32 s53, s53, 896
    buffer_load_dwordx4 a[28:31], v5, s[32:35], s53 offen offset:672
    s_waitcnt vmcnt(6)
    v_mfma_f32_16x16x32_bf16 v[16:19], v[112:115], v[80:83], v[16:19]
    buffer_load_dwordx4 v[100:103], v2, s[20:23], s80 offen offset:2048 nt
    s_waitcnt vmcnt(6)
    v_mfma_f32_16x16x32_bf16 v[16:19], v[116:119], v[84:87], v[16:19]
    buffer_load_dwordx4 v[104:107], v2, s[20:23], s80 offen offset:2304 nt
    s_add_u32 s53, s76, 2
    s_and_b32 s53, s53, 15
    s_mul_i32 s53, s53, 896
    buffer_load_dwordx4 a[32:35], v5, s[32:35], s53 offen offset:0
    s_waitcnt vmcnt(7)
    v_mfma_f32_16x16x32_bf16 v[16:19], v[120:123], v[88:91], v[16:19]
    s_add_u32 s53, s80, 16384
    buffer_load_dwordx4 v[108:111], v2, s[20:23], s53 offen offset:0 nt
    s_nop 7
    v_mov_b32_dpp v13, v16 quad_perm:[0,0,0,0] row_mask:0xf bank_mask:0xf
    v_mov_b32_dpp v14, v18 quad_perm:[2,2,2,2] row_mask:0xf bank_mask:0xf
    s_nop 0
    v_add_f32_dpp v13, v17, v13 quad_perm:[1,1,1,1] row_mask:0xf bank_mask:0xf
    v_add_f32_dpp v14, v19, v14 quad_perm:[3,3,3,3] row_mask:0xf bank_mask:0xf
    v_add_f32 v13, v13, v14
    ds_write_b32 v7, v13 offset:2048
    v_max_f32 v8, v8, v13
    s_mov_b32 s52, s80
    s_add_u32 s80, s80, 32768
    s_and_b32 s80, s80, 0xfffff
    s_waitcnt vmcnt(6)
    v_mfma_f32_16x16x32_bf16 v[16:19], v[92:95], v[60:63], 0
    s_add_u32 s53, s52, 16384
    buffer_load_dwordx4 v[112:115], v2, s[20:23], s53 offen offset:256 nt
    s_add_u32 s53, s52, 16384
    buffer_load_dwordx4 v[116:119], v2, s[20:23], s53 offen offset:2048 nt
    s_waitcnt vmcnt(7)
    v_mfma_f32_16x16x32_bf16 v[16:19], v[96:99], v[64:67], v[16:19]
    s_add_u32 s53, s52, 16384
    buffer_load_dwordx4 v[120:123], v2, s[20:23], s53 offen offset:2304 nt
    s_add_u32 s53, s76, 2
    s_and_b32 s53, s53, 15
    s_mul_i32 s53, s53, 896
    buffer_load_dwordx4 a[36:39], v5, s[32:35], s53 offen offset:224
    s_waitcnt vmcnt(7)
    v_mfma_f32_16x16x32_bf16 v[16:19], v[100:103], v[68:71], v[16:19]
    buffer_load_dwordx4 v[92:95], v2, s[20:23], s80 offen offset:0 nt
    s_waitcnt vmcnt(7)
    v_mfma_f32_16x16x32_bf16 v[16:19], v[104:107], v[72:75], v[16:19]
    buffer_load_dwordx4 v[96:99], v2, s[20:23], s80 offen offset:256 nt
    s_waitcnt vmcnt(6)
    v_mfma_f32_16x16x32_bf16 v[16:19], v[108:111], v[76:79], v[16:19]
    s_add_u32 s53, s76, 2
    s_and_b32 s53, s53, 15
    s_mul_i32 s53, s53, 896
    buffer_load_dwordx4 a[40:43], v5, s[32:35], s53 offen offset:448
    s_waitcnt vmcnt(6)
    v_mfma_f32_16x16x32_bf16 v[16:19], v[112:115], v[80:83], v[16:19]
    buffer_load_dwordx4 v[100:103], v2, s[20:23], s80 offen offset:2048 nt
    s_waitcnt vmcnt(6)
    v_mfma_f32_16x16x32_bf16 v[16:19], v[116:119], v[84:87], v[16:19]
    buffer_load_dwordx4 v[104:107], v2, s[20:23], s80 offen offset:2304 nt
    s_add_u32 s53, s76, 2
    s_and_b32 s53, s53, 15
    s_mul_i32 s53, s53, 896
    buffer_load_dwordx4 a[44:47], v5, s[32:35], s53 offen offset:672
    s_waitcnt vmcnt(7)
    v_mfma_f32_16x16x32_bf16 v[16:19], v[120:123], v[88:91], v[16:19]
    s_add_u32 s53, s80, 16384
    buffer_load_dwordx4 v[108:111], v2, s[20:23], s53 offen offset:0 nt
    s_nop 7
    v_mov_b32_dpp v13, v16 quad_perm:[0,0,0,0] row_mask:0xf bank_mask:0xf
    v_mov_b32_dpp v14, v18 quad_perm:[2,2,2,2] row_mask:0xf bank_mask:0xf
    s_nop 0
    v_add_f32_dpp v13, v17, v13 quad_perm:[1,1,1,1] row_mask:0xf bank_mask:0xf
    v_add_f32_dpp v14, v19, v14 quad_perm:[3,3,3,3] row_mask:0xf bank_mask:0xf
    v_add_f32 v13, v13, v14
    ds_write_b32 v7, v13 offset:2304
    v_max_f32 v8, v8, v13
    s_mov_b32 s52, s80
    s_add_u32 s80, s80, 32768
    s_and_b32 s80, s80, 0xfffff
    s_waitcnt vmcnt(6)
    v_mfma_f32_16x16x32_bf16 v[16:19], v[92:95], v[60:63], 0
    s_add_u32 s53, s52, 16384
    buffer_load_dwordx4 v[112:115], v2, s[20:23], s53 offen offset:256 nt
    s_add_u32 s53, s52, 16384
    buffer_load_dwordx4 v[116:119], v2, s[20:23], s53 offen offset:2048 nt
    s_waitcnt vmcnt(7)
    v_mfma_f32_16x16x32_bf16 v[16:19], v[96:99], v[64:67], v[16:19]
    s_add_u32 s53, s52, 16384
    buffer_load_dwordx4 v[120:123], v2, s[20:23], s53 offen offset:2304 nt
    s_add_u32 s53, s76, 3
    s_and_b32 s53, s53, 15
    s_mul_i32 s53, s53, 896
    buffer_load_dwordx4 a[48:51], v5, s[32:35], s53 offen offset:0
    s_waitcnt vmcnt(7)
    v_mfma_f32_16x16x32_bf16 v[16:19], v[100:103], v[68:71], v[16:19]
    buffer_load_dwordx4 v[92:95], v2, s[20:23], s80 offen offset:0 nt
    s_waitcnt vmcnt(7)
    v_mfma_f32_16x16x32_bf16 v[16:19], v[104:107], v[72:75], v[16:19]
    buffer_load_dwordx4 v[96:99], v2, s[20:23], s80 offen offset:256 nt
    s_waitcnt vmcnt(6)
    v_mfma_f32_16x16x32_bf16 v[16:19], v[108:111], v[76:79], v[16:19]
    s_add_u32 s53, s76, 3
    s_and_b32 s53, s53, 15
    s_mul_i32 s53, s53, 896
    buffer_load_dwordx4 a[52:55], v5, s[32:35], s53 offen offset:224
    s_waitcnt vmcnt(6)
    v_mfma_f32_16x16x32_bf16 v[16:19], v[112:115], v[80:83], v[16:19]
    buffer_load_dwordx4 v[100:103], v2, s[20:23], s80 offen offset:2048 nt
    s_waitcnt vmcnt(6)
    v_mfma_f32_16x16x32_bf16 v[16:19], v[116:119], v[84:87], v[16:19]
    buffer_load_dwordx4 v[104:107], v2, s[20:23], s80 offen offset:2304 nt
    s_add_u32 s53, s76, 3
    s_and_b32 s53, s53, 15
    s_mul_i32 s53, s53, 896
    buffer_load_dwordx4 a[56:59], v5, s[32:35], s53 offen offset:448
    s_waitcnt vmcnt(7)
    v_mfma_f32_16x16x32_bf16 v[16:19], v[120:123], v[88:91], v[16:19]
    s_add_u32 s53, s80, 16384
    buffer_load_dwordx4 v[108:111], v2, s[20:23], s53 offen offset:0 nt
    s_nop 7
    v_mov_b32_dpp v13, v16 quad_perm:[0,0,0,0] row_mask:0xf bank_mask:0xf
    v_mov_b32_dpp v14, v18 quad_perm:[2,2,2,2] row_mask:0xf bank_mask:0xf
    s_nop 0
    v_add_f32_dpp v13, v17, v13 quad_perm:[1,1,1,1] row_mask:0xf bank_mask:0xf
    v_add_f32_dpp v14, v19, v14 quad_perm:[3,3,3,3] row_mask:0xf bank_mask:0xf
    v_add_f32 v13, v13, v14
    ds_write_b32 v7, v13 offset:2560
    v_max_f32 v8, v8, v13
    s_mov_b32 s52, s80
    s_add_u32 s80, s80, 32768
    s_and_b32 s80, s80, 0xfffff
    s_waitcnt vmcnt(6)
    v_mfma_f32_16x16x32_bf16 v[16:19], v[92:95], v[60:63], 0
    s_add_u32 s53, s52, 16384
    buffer_load_dwordx4 v[112:115], v2, s[20:23], s53 offen offset:256 nt
    s_add_u32 s53, s52, 16384
    buffer_load_dwordx4 v[116:119], v2, s[20:23], s53 offen offset:2048 nt
    s_waitcnt vmcnt(7)
    v_mfma_f32_16x16x32_bf16 v[16:19], v[96:99], v[64:67], v[16:19]
    s_add_u32 s53, s52, 16384
    buffer_load_dwordx4 v[120:123], v2, s[20:23], s53 offen offset:2304 nt
    s_add_u32 s53, s76, 3
    s_and_b32 s53, s53, 15
    s_mul_i32 s53, s53, 896
    buffer_load_dwordx4 a[60:63], v5, s[32:35], s53 offen offset:672
    s_waitcnt vmcnt(7)
    v_mfma_f32_16x16x32_bf16 v[16:19], v[100:103], v[68:71], v[16:19]
    buffer_load_dwordx4 v[92:95], v2, s[20:23], s80 offen offset:0 nt
    s_waitcnt vmcnt(7)
    v_mfma_f32_16x16x32_bf16 v[16:19], v[104:107], v[72:75], v[16:19]
    buffer_load_dwordx4 v[96:99], v2, s[20:23], s80 offen offset:256 nt
    s_waitcnt vmcnt(6)
    v_mfma_f32_16x16x32_bf16 v[16:19], v[108:111], v[76:79], v[16:19]
    s_add_u32 s53, s76, 4
    s_and_b32 s53, s53, 15
    s_mul_i32 s53, s53, 896
    buffer_load_dwordx4 a[64:67], v5, s[32:35], s53 offen offset:0
    s_waitcnt vmcnt(6)
    v_mfma_f32_16x16x32_bf16 v[16:19], v[112:115], v[80:83], v[16:19]
    buffer_load_dwordx4 v[100:103], v2, s[20:23], s80 offen offset:2048 nt
    s_waitcnt vmcnt(6)
    v_mfma_f32_16x16x32_bf16 v[16:19], v[116:119], v[84:87], v[16:19]
    buffer_load_dwordx4 v[104:107], v2, s[20:23], s80 offen offset:2304 nt
    s_add_u32 s53, s76, 4
    s_and_b32 s53, s53, 15
    s_mul_i32 s53, s53, 896
    buffer_load_dwordx4 a[68:71], v5, s[32:35], s53 offen offset:224
    s_waitcnt vmcnt(7)
    v_mfma_f32_16x16x32_bf16 v[16:19], v[120:123], v[88:91], v[16:19]
    s_add_u32 s53, s80, 16384
    buffer_load_dwordx4 v[108:111], v2, s[20:23], s53 offen offset:0 nt
    s_nop 7
    v_mov_b32_dpp v13, v16 quad_perm:[0,0,0,0] row_mask:0xf bank_mask:0xf
    v_mov_b32_dpp v14, v18 quad_perm:[2,2,2,2] row_mask:0xf bank_mask:0xf
    s_nop 0
    v_add_f32_dpp v13, v17, v13 quad_perm:[1,1,1,1] row_mask:0xf bank_mask:0xf
    v_add_f32_dpp v14, v19, v14 quad_perm:[3,3,3,3] row_mask:0xf bank_mask:0xf
    v_add_f32 v13, v13, v14
    ds_write_b32 v7, v13 offset:2816
    v_max_f32 v8, v8, v13
    s_mov_b32 s52, s80
    s_add_u32 s80, s80, 32768
    s_and_b32 s80, s80, 0xfffff
    s_waitcnt vmcnt(6)
    v_mfma_f32_16x16x32_bf16 v[16:19], v[92:95], v[60:63], 0
    s_add_u32 s53, s52, 16384
    buffer_load_dwordx4 v[112:115], v2, s[20:23], s53 offen offset:256 nt
    s_add_u32 s53, s52, 16384
    buffer_load_dwordx4 v[116:119], v2, s[20:23], s53 offen offset:2048 nt
    s_waitcnt vmcnt(7)
    v_mfma_f32_16x16x32_bf16 v[16:19], v[96:99], v[64:67], v[16:19]
    s_add_u32 s53, s52, 16384
    buffer_load_dwordx4 v[120:123], v2, s[20:23], s53 offen offset:2304 nt
    s_add_u32 s53, s76, 4
    s_and_b32 s53, s53, 15
    s_mul_i32 s53, s53, 896
    buffer_load_dwordx4 a[72:75], v5, s[32:35], s53 offen offset:448
    s_waitcnt vmcnt(7)
    v_mfma_f32_16x16x32_bf16 v[16:19], v[100:103], v[68:71], v[16:19]
    buffer_load_dwordx4 v[92:95], v2, s[20:23], s80 offen offset:0 nt
    s_waitcnt vmcnt(7)
    v_mfma_f32_16x16x32_bf16 v[16:19], v[104:107], v[72:75], v[16:19]
    buffer_load_dwordx4 v[96:99], v2, s[20:23], s80 offen offset:256 nt
    s_waitcnt vmcnt(6)
    v_mfma_f32_16x16x32_bf16 v[16:19], v[108:111], v[76:79], v[16:19]
    s_add_u32 s53, s76, 4
    s_and_b32 s53, s53, 15
    s_mul_i32 s53, s53, 896
    buffer_load_dwordx4 a[76:79], v5, s[32:35], s53 offen offset:672
    s_waitcnt vmcnt(6)
    v_mfma_f32_16x16x32_bf16 v[16:19], v[112:115], v[80:83], v[16:19]
    buffer_load_dwordx4 v[100:103], v2, s[20:23], s80 offen offset:2048 nt
    s_waitcnt vmcnt(6)
    v_mfma_f32_16x16x32_bf16 v[16:19], v[116:119], v[84:87], v[16:19]
    buffer_load_dwordx4 v[104:107], v2, s[20:23], s80 offen offset:2304 nt
    s_add_u32 s53, s76, 5
    s_and_b32 s53, s53, 15
    s_mul_i32 s53, s53, 896
    buffer_load_dwordx4 a[80:83], v5, s[32:35], s53 offen offset:0
    s_waitcnt vmcnt(7)
    v_mfma_f32_16x16x32_bf16 v[16:19], v[120:123], v[88:91], v[16:19]
    s_add_u32 s53, s80, 16384
    buffer_load_dwordx4 v[108:111], v2, s[20:23], s53 offen offset:0 nt
    s_nop 7
    v_mov_b32_dpp v13, v16 quad_perm:[0,0,0,0] row_mask:0xf bank_mask:0xf
    v_mov_b32_dpp v14, v18 quad_perm:[2,2,2,2] row_mask:0xf bank_mask:0xf
    s_nop 0
    v_add_f32_dpp v13, v17, v13 quad_perm:[1,1,1,1] row_mask:0xf bank_mask:0xf
    v_add_f32_dpp v14, v19, v14 quad_perm:[3,3,3,3] row_mask:0xf bank_mask:0xf
    v_add_f32 v13, v13, v14
    ds_write_b32 v7, v13 offset:3072
    v_max_f32 v8, v8, v13
    s_mov_b32 s52, s80
    s_add_u32 s80, s80, 32768
    s_and_b32 s80, s80, 0xfffff
    s_waitcnt vmcnt(6)
    v_mfma_f32_16x16x32_bf16 v[16:19], v[92:95], v[60:63], 0
    s_add_u32 s53, s52, 16384
    buffer_load_dwordx4 v[112:115], v2, s[20:23], s53 offen offset:256 nt
    s_add_u32 s53, s52, 16384
    buffer_load_dwordx4 v[116:119], v2, s[20:23], s53 offen offset:2048 nt
    s_waitcnt vmcnt(7)
    v_mfma_f32_16x16x32_bf16 v[16:19], v[96:99], v[64:67], v[16:19]
    s_add_u32 s53, s52, 16384
    buffer_load_dwordx4 v[120:123], v2, s[20:23], s53 offen offset:2304 nt
    s_add_u32 s53, s76, 5
    s_and_b32 s53, s53, 15
    s_mul_i32 s53, s53, 896
    buffer_load_dwordx4 a[84:87], v5, s[32:35], s53 offen offset:224
    s_waitcnt vmcnt(7)
    v_mfma_f32_16x16x32_bf16 v[16:19], v[100:103], v[68:71], v[16:19]
    buffer_load_dwordx4 v[92:95], v2, s[20:23], s80 offen offset:0 nt
    s_waitcnt vmcnt(7)
    v_mfma_f32_16x16x32_bf16 v[16:19], v[104:107], v[72:75], v[16:19]
    buffer_load_dwordx4 v[96:99], v2, s[20:23], s80 offen offset:256 nt
    s_waitcnt vmcnt(6)
    v_mfma_f32_16x16x32_bf16 v[16:19], v[108:111], v[76:79], v[16:19]
    s_add_u32 s53, s76, 5
    s_and_b32 s53, s53, 15
    s_mul_i32 s53, s53, 896
    buffer_load_dwordx4 a[88:91], v5, s[32:35], s53 offen offset:448
    s_waitcnt vmcnt(6)
    v_mfma_f32_16x16x32_bf16 v[16:19], v[112:115], v[80:83], v[16:19]
    buffer_load_dwordx4 v[100:103], v2, s[20:23], s80 offen offset:2048 nt
    s_waitcnt vmcnt(6)
    v_mfma_f32_16x16x32_bf16 v[16:19], v[116:119], v[84:87], v[16:19]
    buffer_load_dwordx4 v[104:107], v2, s[20:23], s80 offen offset:2304 nt
    s_add_u32 s53, s76, 5
    s_and_b32 s53, s53, 15
    s_mul_i32 s53, s53, 896
    buffer_load_dwordx4 a[92:95], v5, s[32:35], s53 offen offset:672
    s_waitcnt vmcnt(7)
    v_mfma_f32_16x16x32_bf16 v[16:19], v[120:123], v[88:91], v[16:19]
    s_add_u32 s53, s80, 16384
    buffer_load_dwordx4 v[108:111], v2, s[20:23], s53 offen offset:0 nt
    s_nop 7
    v_mov_b32_dpp v13, v16 quad_perm:[0,0,0,0] row_mask:0xf bank_mask:0xf
    v_mov_b32_dpp v14, v18 quad_perm:[2,2,2,2] row_mask:0xf bank_mask:0xf
    s_nop 0
    v_add_f32_dpp v13, v17, v13 quad_perm:[1,1,1,1] row_mask:0xf bank_mask:0xf
    v_add_f32_dpp v14, v19, v14 quad_perm:[3,3,3,3] row_mask:0xf bank_mask:0xf
    v_add_f32 v13, v13, v14
    ds_write_b32 v7, v13 offset:3328
    v_max_f32 v8, v8, v13
    s_mov_b32 s52, s80
    s_add_u32 s80, s80, 32768
    s_and_b32 s80, s80, 0xfffff
    s_waitcnt vmcnt(6)
    v_mfma_f32_16x16x32_bf16 v[16:19], v[92:95], v[60:63], 0
    s_add_u32 s53, s52, 16384
    buffer_load_dwordx4 v[112:115], v2, s[20:23], s53 offen offset:256 nt
    s_add_u32 s53, s52, 16384
    buffer_load_dwordx4 v[116:119], v2, s[20:23], s53 offen offset:2048 nt
    s_waitcnt vmcnt(7)
    v_mfma_f32_16x16x32_bf16 v[16:19], v[96:99], v[64:67], v[16:19]
    s_add_u32 s53, s52, 16384
    buffer_load_dwordx4 v[120:123], v2, s[20:23], s53 offen offset:2304 nt
    s_add_u32 s53, s76, 6
    s_and_b32 s53, s53, 15
    s_mul_i32 s53, s53, 896
    buffer_load_dwordx4 a[96:99], v5, s[32:35], s53 offen offset:0
    s_waitcnt vmcnt(7)
    v_mfma_f32_16x16x32_bf16 v[16:19], v[100:103], v[68:71], v[16:19]
    buffer_load_dwordx4 v[92:95], v2, s[20:23], s80 offen offset:0 nt
    s_waitcnt vmcnt(7)
    v_mfma_f32_16x16x32_bf16 v[16:19], v[104:107], v[72:75], v[16:19]
    buffer_load_dwordx4 v[96:99], v2, s[20:23], s80 offen offset:256 nt
    s_waitcnt vmcnt(6)
    v_mfma_f32_16x16x32_bf16 v[16:19], v[108:111], v[76:79], v[16:19]
    s_add_u32 s53, s76, 6
    s_and_b32 s53, s53, 15
    s_mul_i32 s53, s53, 896
    buffer_load_dwordx4 a[100:103], v5, s[32:35], s53 offen offset:224
    s_waitcnt vmcnt(6)
    v_mfma_f32_16x16x32_bf16 v[16:19], v[112:115], v[80:83], v[16:19]
    buffer_load_dwordx4 v[100:103], v2, s[20:23], s80 offen offset:2048 nt
    s_waitcnt vmcnt(6)
    v_mfma_f32_16x16x32_bf16 v[16:19], v[116:119], v[84:87], v[16:19]
    buffer_load_dwordx4 v[104:107], v2, s[20:23], s80 offen offset:2304 nt
    s_add_u32 s53, s76, 6
    s_and_b32 s53, s53, 15
    s_mul_i32 s53, s53, 896
    buffer_load_dwordx4 a[104:107], v5, s[32:35], s53 offen offset:448
    s_waitcnt vmcnt(7)
    v_mfma_f32_16x16x32_bf16 v[16:19], v[120:123], v[88:91], v[16:19]
    s_add_u32 s53, s80, 16384
    buffer_load_dwordx4 v[108:111], v2, s[20:23], s53 offen offset:0 nt
    s_nop 7
    v_mov_b32_dpp v13, v16 quad_perm:[0,0,0,0] row_mask:0xf bank_mask:0xf
    v_mov_b32_dpp v14, v18 quad_perm:[2,2,2,2] row_mask:0xf bank_mask:0xf
    s_nop 0
    v_add_f32_dpp v13, v17, v13 quad_perm:[1,1,1,1] row_mask:0xf bank_mask:0xf
    v_add_f32_dpp v14, v19, v14 quad_perm:[3,3,3,3] row_mask:0xf bank_mask:0xf
    v_add_f32 v13, v13, v14
    ds_write_b32 v7, v13 offset:3584
    v_max_f32 v8, v8, v13
    s_mov_b32 s52, s80
    s_add_u32 s80, s80, 32768
    s_and_b32 s80, s80, 0xfffff
    s_waitcnt vmcnt(6)
    v_mfma_f32_16x16x32_bf16 v[16:19], v[92:95], v[60:63], 0
    s_add_u32 s53, s52, 16384
    buffer_load_dwordx4 v[112:115], v2, s[20:23], s53 offen offset:256 nt
    s_add_u32 s53, s52, 16384
    buffer_load_dwordx4 v[116:119], v2, s[20:23], s53 offen offset:2048 nt
    s_waitcnt vmcnt(7)
    v_mfma_f32_16x16x32_bf16 v[16:19], v[96:99], v[64:67], v[16:19]
    s_add_u32 s53, s52, 16384
    buffer_load_dwordx4 v[120:123], v2, s[20:23], s53 offen offset:2304 nt
    s_add_u32 s53, s76, 6
    s_and_b32 s53, s53, 15
    s_mul_i32 s53, s53, 896
    buffer_load_dwordx4 a[108:111], v5, s[32:35], s53 offen offset:672
    s_waitcnt vmcnt(7)
    v_mfma_f32_16x16x32_bf16 v[16:19], v[100:103], v[68:71], v[16:19]
    buffer_load_dwordx4 v[92:95], v2, s[20:23], s80 offen offset:0 nt
    s_waitcnt vmcnt(7)
    v_mfma_f32_16x16x32_bf16 v[16:19], v[104:107], v[72:75], v[16:19]
    buffer_load_dwordx4 v[96:99], v2, s[20:23], s80 offen offset:256 nt
    s_waitcnt vmcnt(6)
    v_mfma_f32_16x16x32_bf16 v[16:19], v[108:111], v[76:79], v[16:19]
    s_add_u32 s53, s76, 7
    s_and_b32 s53, s53, 15
    s_mul_i32 s53, s53, 896
    buffer_load_dwordx4 a[112:115], v5, s[32:35], s53 offen offset:0
    s_waitcnt vmcnt(6)
    v_mfma_f32_16x16x32_bf16 v[16:19], v[112:115], v[80:83], v[16:19]
    buffer_load_dwordx4 v[100:103], v2, s[20:23], s80 offen offset:2048 nt
    s_waitcnt vmcnt(6)
    v_mfma_f32_16x16x32_bf16 v[16:19], v[116:119], v[84:87], v[16:19]
    buffer_load_dwordx4 v[104:107], v2, s[20:23], s80 offen offset:2304 nt
    s_add_u32 s53, s76, 7
    s_and_b32 s53, s53, 15
    s_mul_i32 s53, s53, 896
    buffer_load_dwordx4 a[116:119], v5, s[32:35], s53 offen offset:224
    s_waitcnt vmcnt(7)
    v_mfma_f32_16x16x32_bf16 v[16:19], v[120:123], v[88:91], v[16:19]
    s_add_u32 s53, s80, 16384
    buffer_load_dwordx4 v[108:111], v2, s[20:23], s53 offen offset:0 nt
    s_nop 7
    v_mov_b32_dpp v13, v16 quad_perm:[0,0,0,0] row_mask:0xf bank_mask:0xf
    v_mov_b32_dpp v14, v18 quad_perm:[2,2,2,2] row_mask:0xf bank_mask:0xf
    s_nop 0
    v_add_f32_dpp v13, v17, v13 quad_perm:[1,1,1,1] row_mask:0xf bank_mask:0xf
    v_add_f32_dpp v14, v19, v14 quad_perm:[3,3,3,3] row_mask:0xf bank_mask:0xf
    v_add_f32 v13, v13, v14
    ds_write_b32 v7, v13 offset:3840
    v_max_f32 v8, v8, v13
    s_mov_b32 s52, s80
    s_add_u32 s80, s80, 32768
    s_and_b32 s80, s80, 0xfffff
    s_waitcnt vmcnt(6)
    v_mfma_f32_16x16x32_bf16 v[16:19], v[92:95], v[60:63], 0
    s_add_u32 s53, s52, 16384
    buffer_load_dwordx4 v[112:115], v2, s[20:23], s53 offen offset:256 nt
    s_add_u32 s53, s52, 16384
    buffer_load_dwordx4 v[116:119], v2, s[20:23], s53 offen offset:2048 nt
    s_waitcnt vmcnt(7)
    v_mfma_f32_16x16x32_bf16 v[16:19], v[96:99], v[64:67], v[16:19]
    s_add_u32 s53, s52, 16384
    buffer_load_dwordx4 v[120:123], v2, s[20:23], s53 offen offset:2304 nt
    s_add_u32 s53, s76, 7
    s_and_b32 s53, s53, 15
    s_mul_i32 s53, s53, 896
    buffer_load_dwordx4 a[120:123], v5, s[32:35], s53 offen offset:448
    s_waitcnt vmcnt(7)
    v_mfma_f32_16x16x32_bf16 v[16:19], v[100:103], v[68:71], v[16:19]
    buffer_load_dwordx4 v[92:95], v2, s[20:23], s80 offen offset:0 nt
    s_waitcnt vmcnt(7)
    v_mfma_f32_16x16x32_bf16 v[16:19], v[104:107], v[72:75], v[16:19]
    buffer_load_dwordx4 v[96:99], v2, s[20:23], s80 offen offset:256 nt
    s_waitcnt vmcnt(6)
    v_mfma_f32_16x16x32_bf16 v[16:19], v[108:111], v[76:79], v[16:19]
    s_add_u32 s53, s76, 7
    s_and_b32 s53, s53, 15
    s_mul_i32 s53, s53, 896
    buffer_load_dwordx4 a[124:127], v5, s[32:35], s53 offen offset:672
    s_waitcnt vmcnt(6)
    v_mfma_f32_16x16x32_bf16 v[16:19], v[112:115], v[80:83], v[16:19]
    buffer_load_dwordx4 v[100:103], v2, s[20:23], s80 offen offset:2048 nt
    s_waitcnt vmcnt(6)
    v_mfma_f32_16x16x32_bf16 v[16:19], v[116:119], v[84:87], v[16:19]
    buffer_load_dwordx4 v[104:107], v2, s[20:23], s80 offen offset:2304 nt
    s_add_u32 s53, s76, 8
    s_and_b32 s53, s53, 15
    s_mul_i32 s53, s53, 896
    buffer_load_dwordx4 a[128:131], v5, s[32:35], s53 offen offset:0
    s_waitcnt vmcnt(7)
    v_mfma_f32_16x16x32_bf16 v[16:19], v[120:123], v[88:91], v[16:19]
    s_add_u32 s53, s80, 16384
    buffer_load_dwordx4 v[108:111], v2, s[20:23], s53 offen offset:0 nt
    s_nop 7
    v_mov_b32_dpp v13, v16 quad_perm:[0,0,0,0] row_mask:0xf bank_mask:0xf
    v_mov_b32_dpp v14, v18 quad_perm:[2,2,2,2] row_mask:0xf bank_mask:0xf
    s_nop 0
    v_add_f32_dpp v13, v17, v13 quad_perm:[1,1,1,1] row_mask:0xf bank_mask:0xf
    v_add_f32_dpp v14, v19, v14 quad_perm:[3,3,3,3] row_mask:0xf bank_mask:0xf
    v_add_f32 v13, v13, v14
    ds_write_b32 v7, v13 offset:4096
    v_max_f32 v8, v8, v13
    s_mov_b32 s52, s80
    s_add_u32 s80, s80, 32768
    s_and_b32 s80, s80, 0xfffff
    s_waitcnt vmcnt(6)
    v_mfma_f32_16x16x32_bf16 v[16:19], v[92:95], v[60:63], 0
    s_add_u32 s53, s52, 16384
    buffer_load_dwordx4 v[112:115], v2, s[20:23], s53 offen offset:256 nt
    s_add_u32 s53, s52, 16384
    buffer_load_dwordx4 v[116:119], v2, s[20:23], s53 offen offset:2048 nt
    s_waitcnt vmcnt(7)
    v_mfma_f32_16x16x32_bf16 v[16:19], v[96:99], v[64:67], v[16:19]
    s_add_u32 s53, s52, 16384
    buffer_load_dwordx4 v[120:123], v2, s[20:23], s53 offen offset:2304 nt
    s_add_u32 s53, s76, 8
    s_and_b32 s53, s53, 15
    s_mul_i32 s53, s53, 896
    buffer_load_dwordx4 a[132:135], v5, s[32:35], s53 offen offset:224
    s_waitcnt vmcnt(7)
    v_mfma_f32_16x16x32_bf16 v[16:19], v[100:103], v[68:71], v[16:19]
    buffer_load_dwordx4 v[92:95], v2, s[20:23], s80 offen offset:0 nt
    s_waitcnt vmcnt(7)
    v_mfma_f32_16x16x32_bf16 v[16:19], v[104:107], v[72:75], v[16:19]
    buffer_load_dwordx4 v[96:99], v2, s[20:23], s80 offen offset:256 nt
    s_waitcnt vmcnt(6)
    v_mfma_f32_16x16x32_bf16 v[16:19], v[108:111], v[76:79], v[16:19]
    s_add_u32 s53, s76, 8
    s_and_b32 s53, s53, 15
    s_mul_i32 s53, s53, 896
    buffer_load_dwordx4 a[136:139], v5, s[32:35], s53 offen offset:448
    s_waitcnt vmcnt(6)
    v_mfma_f32_16x16x32_bf16 v[16:19], v[112:115], v[80:83], v[16:19]
    buffer_load_dwordx4 v[100:103], v2, s[20:23], s80 offen offset:2048 nt
    s_waitcnt vmcnt(6)
    v_mfma_f32_16x16x32_bf16 v[16:19], v[116:119], v[84:87], v[16:19]
    buffer_load_dwordx4 v[104:107], v2, s[20:23], s80 offen offset:2304 nt
    s_add_u32 s53, s76, 8
    s_and_b32 s53, s53, 15
    s_mul_i32 s53, s53, 896
    buffer_load_dwordx4 a[140:143], v5, s[32:35], s53 offen offset:672
    s_waitcnt vmcnt(7)
    v_mfma_f32_16x16x32_bf16 v[16:19], v[120:123], v[88:91], v[16:19]
    s_add_u32 s53, s80, 16384
    buffer_load_dwordx4 v[108:111], v2, s[20:23], s53 offen offset:0 nt
    s_nop 7
    v_mov_b32_dpp v13, v16 quad_perm:[0,0,0,0] row_mask:0xf bank_mask:0xf
    v_mov_b32_dpp v14, v18 quad_perm:[2,2,2,2] row_mask:0xf bank_mask:0xf
    s_nop 0
    v_add_f32_dpp v13, v17, v13 quad_perm:[1,1,1,1] row_mask:0xf bank_mask:0xf
    v_add_f32_dpp v14, v19, v14 quad_perm:[3,3,3,3] row_mask:0xf bank_mask:0xf
    v_add_f32 v13, v13, v14
    ds_write_b32 v7, v13 offset:4352
    v_max_f32 v8, v8, v13
    s_mov_b32 s52, s80
    s_add_u32 s80, s80, 32768
    s_and_b32 s80, s80, 0xfffff
    s_waitcnt vmcnt(6)
    v_mfma_f32_16x16x32_bf16 v[16:19], v[92:95], v[60:63], 0
    s_add_u32 s53, s52, 16384
    buffer_load_dwordx4 v[112:115], v2, s[20:23], s53 offen offset:256 nt
    s_add_u32 s53, s52, 16384
    buffer_load_dwordx4 v[116:119], v2, s[20:23], s53 offen offset:2048 nt
    s_waitcnt vmcnt(7)
    v_mfma_f32_16x16x32_bf16 v[16:19], v[96:99], v[64:67], v[16:19]
    s_add_u32 s53, s52, 16384
    buffer_load_dwordx4 v[120:123], v2, s[20:23], s53 offen offset:2304 nt
    s_add_u32 s53, s76, 9
    s_and_b32 s53, s53, 15
    s_mul_i32 s53, s53, 896
    buffer_load_dwordx4 a[144:147], v5, s[32:35], s53 offen offset:0
    s_waitcnt vmcnt(7)
    v_mfma_f32_16x16x32_bf16 v[16:19], v[100:103], v[68:71], v[16:19]
    buffer_load_dwordx4 v[92:95], v2, s[20:23], s80 offen offset:0 nt
    s_waitcnt vmcnt(7)
    v_mfma_f32_16x16x32_bf16 v[16:19], v[104:107], v[72:75], v[16:19]
    buffer_load_dwordx4 v[96:99], v2, s[20:23], s80 offen offset:256 nt
    s_waitcnt vmcnt(6)
    v_mfma_f32_16x16x32_bf16 v[16:19], v[108:111], v[76:79], v[16:19]
    s_add_u32 s53, s76, 9
    s_and_b32 s53, s53, 15
    s_mul_i32 s53, s53, 896
    buffer_load_dwordx4 a[148:151], v5, s[32:35], s53 offen offset:224
    s_waitcnt vmcnt(6)
    v_mfma_f32_16x16x32_bf16 v[16:19], v[112:115], v[80:83], v[16:19]
    buffer_load_dwordx4 v[100:103], v2, s[20:23], s80 offen offset:2048 nt
    s_waitcnt vmcnt(6)
    v_mfma_f32_16x16x32_bf16 v[16:19], v[116:119], v[84:87], v[16:19]
    buffer_load_dwordx4 v[104:107], v2, s[20:23], s80 offen offset:2304 nt
    s_add_u32 s53, s76, 9
    s_and_b32 s53, s53, 15
    s_mul_i32 s53, s53, 896
    buffer_load_dwordx4 a[152:155], v5, s[32:35], s53 offen offset:448
    s_waitcnt vmcnt(7)
    v_mfma_f32_16x16x32_bf16 v[16:19], v[120:123], v[88:91], v[16:19]
    s_add_u32 s53, s80, 16384
    buffer_load_dwordx4 v[108:111], v2, s[20:23], s53 offen offset:0 nt
    s_nop 7
    v_mov_b32_dpp v13, v16 quad_perm:[0,0,0,0] row_mask:0xf bank_mask:0xf
    v_mov_b32_dpp v14, v18 quad_perm:[2,2,2,2] row_mask:0xf bank_mask:0xf
    s_nop 0
    v_add_f32_dpp v13, v17, v13 quad_perm:[1,1,1,1] row_mask:0xf bank_mask:0xf
    v_add_f32_dpp v14, v19, v14 quad_perm:[3,3,3,3] row_mask:0xf bank_mask:0xf
    v_add_f32 v13, v13, v14
    ds_write_b32 v7, v13 offset:4608
    v_max_f32 v8, v8, v13
    s_mov_b32 s52, s80
    s_add_u32 s80, s80, 32768
    s_and_b32 s80, s80, 0xfffff
    s_waitcnt vmcnt(6)
    v_mfma_f32_16x16x32_bf16 v[16:19], v[92:95], v[60:63], 0
    s_add_u32 s53, s52, 16384
    buffer_load_dwordx4 v[112:115], v2, s[20:23], s53 offen offset:256 nt
    s_add_u32 s53, s52, 16384
    buffer_load_dwordx4 v[116:119], v2, s[20:23], s53 offen offset:2048 nt
    s_waitcnt vmcnt(7)
    v_mfma_f32_16x16x32_bf16 v[16:19], v[96:99], v[64:67], v[16:19]
    s_add_u32 s53, s52, 16384
    buffer_load_dwordx4 v[120:123], v2, s[20:23], s53 offen offset:2304 nt
    s_add_u32 s53, s76, 9
    s_and_b32 s53, s53, 15
    s_mul_i32 s53, s53, 896
    buffer_load_dwordx4 a[156:159], v5, s[32:35], s53 offen offset:672
    s_waitcnt vmcnt(7)
    v_mfma_f32_16x16x32_bf16 v[16:19], v[100:103], v[68:71], v[16:19]
    buffer_load_dwordx4 v[92:95], v2, s[20:23], s80 offen offset:0 nt
    s_waitcnt vmcnt(7)
    v_mfma_f32_16x16x32_bf16 v[16:19], v[104:107], v[72:75], v[16:19]
    buffer_load_dwordx4 v[96:99], v2, s[20:23], s80 offen offset:256 nt
    s_waitcnt vmcnt(6)
    v_mfma_f32_16x16x32_bf16 v[16:19], v[108:111], v[76:79], v[16:19]
    s_add_u32 s53, s76, 10
    s_and_b32 s53, s53, 15
    s_mul_i32 s53, s53, 896
    buffer_load_dwordx4 a[160:163], v5, s[32:35], s53 offen offset:0
    s_waitcnt vmcnt(6)
    v_mfma_f32_16x16x32_bf16 v[16:19], v[112:115], v[80:83], v[16:19]
    buffer_load_dwordx4 v[100:103], v2, s[20:23], s80 offen offset:2048 nt
    s_waitcnt vmcnt(6)
    v_mfma_f32_16x16x32_bf16 v[16:19], v[116:119], v[84:87], v[16:19]
    buffer_load_dwordx4 v[104:107], v2, s[20:23], s80 offen offset:2304 nt
    s_add_u32 s53, s76, 10
    s_and_b32 s53, s53, 15
    s_mul_i32 s53, s53, 896
    buffer_load_dwordx4 a[164:167], v5, s[32:35], s53 offen offset:224
    s_waitcnt vmcnt(7)
    v_mfma_f32_16x16x32_bf16 v[16:19], v[120:123], v[88:91], v[16:19]
    s_add_u32 s53, s80, 16384
    buffer_load_dwordx4 v[108:111], v2, s[20:23], s53 offen offset:0 nt
    s_nop 7
    v_mov_b32_dpp v13, v16 quad_perm:[0,0,0,0] row_mask:0xf bank_mask:0xf
    v_mov_b32_dpp v14, v18 quad_perm:[2,2,2,2] row_mask:0xf bank_mask:0xf
    s_nop 0
    v_add_f32_dpp v13, v17, v13 quad_perm:[1,1,1,1] row_mask:0xf bank_mask:0xf
    v_add_f32_dpp v14, v19, v14 quad_perm:[3,3,3,3] row_mask:0xf bank_mask:0xf
    v_add_f32 v13, v13, v14
    ds_write_b32 v7, v13 offset:4864
    v_max_f32 v8, v8, v13
    s_mov_b32 s52, s80
    s_add_u32 s80, s80, 32768
    s_and_b32 s80, s80, 0xfffff
    s_waitcnt vmcnt(6)
    v_mfma_f32_16x16x32_bf16 v[16:19], v[92:95], v[60:63], 0
    s_add_u32 s53, s52, 16384
    buffer_load_dwordx4 v[112:115], v2, s[20:23], s53 offen offset:256 nt
    s_add_u32 s53, s52, 16384
    buffer_load_dwordx4 v[116:119], v2, s[20:23], s53 offen offset:2048 nt
    s_waitcnt vmcnt(7)
    v_mfma_f32_16x16x32_bf16 v[16:19], v[96:99], v[64:67], v[16:19]
    s_add_u32 s53, s52, 16384
    buffer_load_dwordx4 v[120:123], v2, s[20:23], s53 offen offset:2304 nt
    s_add_u32 s53, s76, 10
    s_and_b32 s53, s53, 15
    s_mul_i32 s53, s53, 896
    buffer_load_dwordx4 a[168:171], v5, s[32:35], s53 offen offset:448
    s_waitcnt vmcnt(7)
    v_mfma_f32_16x16x32_bf16 v[16:19], v[100:103], v[68:71], v[16:19]
    buffer_load_dwordx4 v[92:95], v2, s[20:23], s80 offen offset:0 nt
    s_waitcnt vmcnt(7)
    v_mfma_f32_16x16x32_bf16 v[16:19], v[104:107], v[72:75], v[16:19]
    buffer_load_dwordx4 v[96:99], v2, s[20:23], s80 offen offset:256 nt
    s_waitcnt vmcnt(6)
    v_mfma_f32_16x16x32_bf16 v[16:19], v[108:111], v[76:79], v[16:19]
    s_add_u32 s53, s76, 10
    s_and_b32 s53, s53, 15
    s_mul_i32 s53, s53, 896
    buffer_load_dwordx4 a[172:175], v5, s[32:35], s53 offen offset:672
    s_waitcnt vmcnt(6)
    v_mfma_f32_16x16x32_bf16 v[16:19], v[112:115], v[80:83], v[16:19]
    buffer_load_dwordx4 v[100:103], v2, s[20:23], s80 offen offset:2048 nt
    s_waitcnt vmcnt(6)
    v_mfma_f32_16x16x32_bf16 v[16:19], v[116:119], v[84:87], v[16:19]
    buffer_load_dwordx4 v[104:107], v2, s[20:23], s80 offen offset:2304 nt
    s_add_u32 s53, s76, 11
    s_and_b32 s53, s53, 15
    s_mul_i32 s53, s53, 896
    buffer_load_dwordx4 a[176:179], v5, s[32:35], s53 offen offset:0
    s_waitcnt vmcnt(7)
    v_mfma_f32_16x16x32_bf16 v[16:19], v[120:123], v[88:91], v[16:19]
    s_add_u32 s53, s80, 16384
    buffer_load_dwordx4 v[108:111], v2, s[20:23], s53 offen offset:0 nt
    s_nop 7
    v_mov_b32_dpp v13, v16 quad_perm:[0,0,0,0] row_mask:0xf bank_mask:0xf
    v_mov_b32_dpp v14, v18 quad_perm:[2,2,2,2] row_mask:0xf bank_mask:0xf
    s_nop 0
    v_add_f32_dpp v13, v17, v13 quad_perm:[1,1,1,1] row_mask:0xf bank_mask:0xf
    v_add_f32_dpp v14, v19, v14 quad_perm:[3,3,3,3] row_mask:0xf bank_mask:0xf
    v_add_f32 v13, v13, v14
    ds_write_b32 v7, v13 offset:5120
    v_max_f32 v8, v8, v13
    s_mov_b32 s52, s80
    s_add_u32 s80, s80, 32768
    s_and_b32 s80, s80, 0xfffff
    s_waitcnt vmcnt(6)
    v_mfma_f32_16x16x32_bf16 v[16:19], v[92:95], v[60:63], 0
    s_add_u32 s53, s52, 16384
    buffer_load_dwordx4 v[112:115], v2, s[20:23], s53 offen offset:256 nt
    s_add_u32 s53, s52, 16384
    buffer_load_dwordx4 v[116:119], v2, s[20:23], s53 offen offset:2048 nt
    s_waitcnt vmcnt(7)
    v_mfma_f32_16x16x32_bf16 v[16:19], v[96:99], v[64:67], v[16:19]
    s_add_u32 s53, s52, 16384
    buffer_load_dwordx4 v[120:123], v2, s[20:23], s53 offen offset:2304 nt
    s_add_u32 s53, s76, 11
    s_and_b32 s53, s53, 15
    s_mul_i32 s53, s53, 896
    buffer_load_dwordx4 a[180:183], v5, s[32:35], s53 offen offset:224
    s_waitcnt vmcnt(7)
    v_mfma_f32_16x16x32_bf16 v[16:19], v[100:103], v[68:71], v[16:19]
    buffer_load_dwordx4 v[92:95], v2, s[20:23], s80 offen offset:0 nt
    s_waitcnt vmcnt(7)
    v_mfma_f32_16x16x32_bf16 v[16:19], v[104:107], v[72:75], v[16:19]
    buffer_load_dwordx4 v[96:99], v2, s[20:23], s80 offen offset:256 nt
    s_waitcnt vmcnt(6)
    v_mfma_f32_16x16x32_bf16 v[16:19], v[108:111], v[76:79], v[16:19]
    s_add_u32 s53, s76, 11
    s_and_b32 s53, s53, 15
    s_mul_i32 s53, s53, 896
    buffer_load_dwordx4 a[184:187], v5, s[32:35], s53 offen offset:448
    s_waitcnt vmcnt(6)
    v_mfma_f32_16x16x32_bf16 v[16:19], v[112:115], v[80:83], v[16:19]
    buffer_load_dwordx4 v[100:103], v2, s[20:23], s80 offen offset:2048 nt
    s_waitcnt vmcnt(6)
    v_mfma_f32_16x16x32_bf16 v[16:19], v[116:119], v[84:87], v[16:19]
    buffer_load_dwordx4 v[104:107], v2, s[20:23], s80 offen offset:2304 nt
    s_add_u32 s53, s76, 11
    s_and_b32 s53, s53, 15
    s_mul_i32 s53, s53, 896
    buffer_load_dwordx4 a[188:191], v5, s[32:35], s53 offen offset:672
    s_waitcnt vmcnt(7)
    v_mfma_f32_16x16x32_bf16 v[16:19], v[120:123], v[88:91], v[16:19]
    s_add_u32 s53, s80, 16384
    buffer_load_dwordx4 v[108:111], v2, s[20:23], s53 offen offset:0 nt
    s_nop 7
    v_mov_b32_dpp v13, v16 quad_perm:[0,0,0,0] row_mask:0xf bank_mask:0xf
    v_mov_b32_dpp v14, v18 quad_perm:[2,2,2,2] row_mask:0xf bank_mask:0xf
    s_nop 0
    v_add_f32_dpp v13, v17, v13 quad_perm:[1,1,1,1] row_mask:0xf bank_mask:0xf
    v_add_f32_dpp v14, v19, v14 quad_perm:[3,3,3,3] row_mask:0xf bank_mask:0xf
    v_add_f32 v13, v13, v14
    ds_write_b32 v7, v13 offset:5376
    v_max_f32 v8, v8, v13
    s_mov_b32 s52, s80
    s_add_u32 s80, s80, 32768
    s_and_b32 s80, s80, 0xfffff
    s_waitcnt vmcnt(6)
    v_mfma_f32_16x16x32_bf16 v[16:19], v[92:95], v[60:63], 0
    s_add_u32 s53, s52, 16384
    buffer_load_dwordx4 v[112:115], v2, s[20:23], s53 offen offset:256 nt
    s_add_u32 s53, s52, 16384
    buffer_load_dwordx4 v[116:119], v2, s[20:23], s53 offen offset:2048 nt
    s_waitcnt vmcnt(7)
    v_mfma_f32_16x16x32_bf16 v[16:19], v[96:99], v[64:67], v[16:19]
    s_add_u32 s53, s52, 16384
    buffer_load_dwordx4 v[120:123], v2, s[20:23], s53 offen offset:2304 nt
    s_add_u32 s53, s76, 12
    s_and_b32 s53, s53, 15
    s_mul_i32 s53, s53, 896
    buffer_load_dwordx4 a[192:195], v5, s[32:35], s53 offen offset:0
    s_waitcnt vmcnt(7)
    v_mfma_f32_16x16x32_bf16 v[16:19], v[100:103], v[68:71], v[16:19]
    buffer_load_dwordx4 v[92:95], v2, s[20:23], s80 offen offset:0 nt
    s_waitcnt vmcnt(7)
    v_mfma_f32_16x16x32_bf16 v[16:19], v[104:107], v[72:75], v[16:19]
    buffer_load_dwordx4 v[96:99], v2, s[20:23], s80 offen offset:256 nt
    s_waitcnt vmcnt(6)
    v_mfma_f32_16x16x32_bf16 v[16:19], v[108:111], v[76:79], v[16:19]
    s_add_u32 s53, s76, 12
    s_and_b32 s53, s53, 15
    s_mul_i32 s53, s53, 896
    buffer_load_dwordx4 a[196:199], v5, s[32:35], s53 offen offset:224
    s_waitcnt vmcnt(6)
    v_mfma_f32_16x16x32_bf16 v[16:19], v[112:115], v[80:83], v[16:19]
    buffer_load_dwordx4 v[100:103], v2, s[20:23], s80 offen offset:2048 nt
    s_waitcnt vmcnt(6)
    v_mfma_f32_16x16x32_bf16 v[16:19], v[116:119], v[84:87], v[16:19]
    buffer_load_dwordx4 v[104:107], v2, s[20:23], s80 offen offset:2304 nt
    s_add_u32 s53, s76, 12
    s_and_b32 s53, s53, 15
    s_mul_i32 s53, s53, 896
    buffer_load_dwordx4 a[200:203], v5, s[32:35], s53 offen offset:448
    s_waitcnt vmcnt(7)
    v_mfma_f32_16x16x32_bf16 v[16:19], v[120:123], v[88:91], v[16:19]
    s_add_u32 s53, s80, 16384
    buffer_load_dwordx4 v[108:111], v2, s[20:23], s53 offen offset:0 nt
    s_nop 7
    v_mov_b32_dpp v13, v16 quad_perm:[0,0,0,0] row_mask:0xf bank_mask:0xf
    v_mov_b32_dpp v14, v18 quad_perm:[2,2,2,2] row_mask:0xf bank_mask:0xf
    s_nop 0
    v_add_f32_dpp v13, v17, v13 quad_perm:[1,1,1,1] row_mask:0xf bank_mask:0xf
    v_add_f32_dpp v14, v19, v14 quad_perm:[3,3,3,3] row_mask:0xf bank_mask:0xf
    v_add_f32 v13, v13, v14
    ds_write_b32 v7, v13 offset:5632
    v_max_f32 v8, v8, v13
    s_mov_b32 s52, s80
    s_add_u32 s80, s80, 32768
    s_and_b32 s80, s80, 0xfffff
    s_waitcnt vmcnt(6)
    v_mfma_f32_16x16x32_bf16 v[16:19], v[92:95], v[60:63], 0
    s_add_u32 s53, s52, 16384
    buffer_load_dwordx4 v[112:115], v2, s[20:23], s53 offen offset:256 nt
    s_add_u32 s53, s52, 16384
    buffer_load_dwordx4 v[116:119], v2, s[20:23], s53 offen offset:2048 nt
    s_waitcnt vmcnt(7)
    v_mfma_f32_16x16x32_bf16 v[16:19], v[96:99], v[64:67], v[16:19]
    s_add_u32 s53, s52, 16384
    buffer_load_dwordx4 v[120:123], v2, s[20:23], s53 offen offset:2304 nt
    s_add_u32 s53, s76, 12
    s_and_b32 s53, s53, 15
    s_mul_i32 s53, s53, 896
    buffer_load_dwordx4 a[204:207], v5, s[32:35], s53 offen offset:672
    s_waitcnt vmcnt(7)
    v_mfma_f32_16x16x32_bf16 v[16:19], v[100:103], v[68:71], v[16:19]
    buffer_load_dwordx4 v[92:95], v2, s[20:23], s80 offen offset:0 nt
    s_waitcnt vmcnt(7)
    v_mfma_f32_16x16x32_bf16 v[16:19], v[104:107], v[72:75], v[16:19]
    buffer_load_dwordx4 v[96:99], v2, s[20:23], s80 offen offset:256 nt
    s_waitcnt vmcnt(6)
    v_mfma_f32_16x16x32_bf16 v[16:19], v[108:111], v[76:79], v[16:19]
    s_add_u32 s53, s76, 13
    s_and_b32 s53, s53, 15
    s_mul_i32 s53, s53, 896
    buffer_load_dwordx4 a[208:211], v5, s[32:35], s53 offen offset:0
    s_waitcnt vmcnt(6)
    v_mfma_f32_16x16x32_bf16 v[16:19], v[112:115], v[80:83], v[16:19]
    buffer_load_dwordx4 v[100:103], v2, s[20:23], s80 offen offset:2048 nt
    s_waitcnt vmcnt(6)
    v_mfma_f32_16x16x32_bf16 v[16:19], v[116:119], v[84:87], v[16:19]
    buffer_load_dwordx4 v[104:107], v2, s[20:23], s80 offen offset:2304 nt
    s_add_u32 s53, s76, 13
    s_and_b32 s53, s53, 15
    s_mul_i32 s53, s53, 896
    buffer_load_dwordx4 a[212:215], v5, s[32:35], s53 offen offset:224
    s_waitcnt vmcnt(7)
    v_mfma_f32_16x16x32_bf16 v[16:19], v[120:123], v[88:91], v[16:19]
    s_add_u32 s53, s80, 16384
    buffer_load_dwordx4 v[108:111], v2, s[20:23], s53 offen offset:0 nt
    s_nop 7
    v_mov_b32_dpp v13, v16 quad_perm:[0,0,0,0] row_mask:0xf bank_mask:0xf
    v_mov_b32_dpp v14, v18 quad_perm:[2,2,2,2] row_mask:0xf bank_mask:0xf
    s_nop 0
    v_add_f32_dpp v13, v17, v13 quad_perm:[1,1,1,1] row_mask:0xf bank_mask:0xf
    v_add_f32_dpp v14, v19, v14 quad_perm:[3,3,3,3] row_mask:0xf bank_mask:0xf
    v_add_f32 v13, v13, v14
    ds_write_b32 v7, v13 offset:5888
    v_max_f32 v8, v8, v13
    s_mov_b32 s52, s80
    s_add_u32 s80, s80, 32768
    s_and_b32 s80, s80, 0xfffff
    s_waitcnt vmcnt(6)
    v_mfma_f32_16x16x32_bf16 v[16:19], v[92:95], v[60:63], 0
    s_add_u32 s53, s52, 16384
    buffer_load_dwordx4 v[112:115], v2, s[20:23], s53 offen offset:256 nt
    s_add_u32 s53, s52, 16384
    buffer_load_dwordx4 v[116:119], v2, s[20:23], s53 offen offset:2048 nt
    s_waitcnt vmcnt(7)
    v_mfma_f32_16x16x32_bf16 v[16:19], v[96:99], v[64:67], v[16:19]
    s_add_u32 s53, s52, 16384
    buffer_load_dwordx4 v[120:123], v2, s[20:23], s53 offen offset:2304 nt
    s_add_u32 s53, s76, 13
    s_and_b32 s53, s53, 15
    s_mul_i32 s53, s53, 896
    buffer_load_dwordx4 a[216:219], v5, s[32:35], s53 offen offset:448
    s_waitcnt vmcnt(7)
    v_mfma_f32_16x16x32_bf16 v[16:19], v[100:103], v[68:71], v[16:19]
    buffer_load_dwordx4 v[92:95], v2, s[20:23], s80 offen offset:0 nt
    s_waitcnt vmcnt(7)
    v_mfma_f32_16x16x32_bf16 v[16:19], v[104:107], v[72:75], v[16:19]
    buffer_load_dwordx4 v[96:99], v2, s[20:23], s80 offen offset:256 nt
    s_waitcnt vmcnt(6)
    v_mfma_f32_16x16x32_bf16 v[16:19], v[108:111], v[76:79], v[16:19]
    s_add_u32 s53, s76, 13
    s_and_b32 s53, s53, 15
    s_mul_i32 s53, s53, 896
    buffer_load_dwordx4 a[220:223], v5, s[32:35], s53 offen offset:672
    s_waitcnt vmcnt(6)
    v_mfma_f32_16x16x32_bf16 v[16:19], v[112:115], v[80:83], v[16:19]
    buffer_load_dwordx4 v[100:103], v2, s[20:23], s80 offen offset:2048 nt
    s_waitcnt vmcnt(6)
    v_mfma_f32_16x16x32_bf16 v[16:19], v[116:119], v[84:87], v[16:19]
    buffer_load_dwordx4 v[104:107], v2, s[20:23], s80 offen offset:2304 nt
    s_add_u32 s53, s76, 14
    s_and_b32 s53, s53, 15
    s_mul_i32 s53, s53, 896
    buffer_load_dwordx4 a[224:227], v5, s[32:35], s53 offen offset:0
    s_waitcnt vmcnt(7)
    v_mfma_f32_16x16x32_bf16 v[16:19], v[120:123], v[88:91], v[16:19]
    s_add_u32 s53, s80, 16384
    buffer_load_dwordx4 v[108:111], v2, s[20:23], s53 offen offset:0 nt
    s_nop 7
    v_mov_b32_dpp v13, v16 quad_perm:[0,0,0,0] row_mask:0xf bank_mask:0xf
    v_mov_b32_dpp v14, v18 quad_perm:[2,2,2,2] row_mask:0xf bank_mask:0xf
    s_nop 0
    v_add_f32_dpp v13, v17, v13 quad_perm:[1,1,1,1] row_mask:0xf bank_mask:0xf
    v_add_f32_dpp v14, v19, v14 quad_perm:[3,3,3,3] row_mask:0xf bank_mask:0xf
    v_add_f32 v13, v13, v14
    ds_write_b32 v7, v13 offset:6144
    v_max_f32 v8, v8, v13
    s_mov_b32 s52, s80
    s_add_u32 s80, s80, 32768
    s_and_b32 s80, s80, 0xfffff
    s_waitcnt vmcnt(6)
    v_mfma_f32_16x16x32_bf16 v[16:19], v[92:95], v[60:63], 0
    s_add_u32 s53, s52, 16384
    buffer_load_dwordx4 v[112:115], v2, s[20:23], s53 offen offset:256 nt
    s_add_u32 s53, s52, 16384
    buffer_load_dwordx4 v[116:119], v2, s[20:23], s53 offen offset:2048 nt
    s_waitcnt vmcnt(7)
    v_mfma_f32_16x16x32_bf16 v[16:19], v[96:99], v[64:67], v[16:19]
    s_add_u32 s53, s52, 16384
    buffer_load_dwordx4 v[120:123], v2, s[20:23], s53 offen offset:2304 nt
    s_add_u32 s53, s76, 14
    s_and_b32 s53, s53, 15
    s_mul_i32 s53, s53, 896
    buffer_load_dwordx4 a[228:231], v5, s[32:35], s53 offen offset:224
    s_waitcnt vmcnt(7)
    v_mfma_f32_16x16x32_bf16 v[16:19], v[100:103], v[68:71], v[16:19]
    buffer_load_dwordx4 v[92:95], v2, s[20:23], s80 offen offset:0 nt
    s_waitcnt vmcnt(7)
    v_mfma_f32_16x16x32_bf16 v[16:19], v[104:107], v[72:75], v[16:19]
    buffer_load_dwordx4 v[96:99], v2, s[20:23], s80 offen offset:256 nt
    s_waitcnt vmcnt(6)
    v_mfma_f32_16x16x32_bf16 v[16:19], v[108:111], v[76:79], v[16:19]
    s_add_u32 s53, s76, 14
    s_and_b32 s53, s53, 15
    s_mul_i32 s53, s53, 896
    buffer_load_dwordx4 a[232:235], v5, s[32:35], s53 offen offset:448
    s_waitcnt vmcnt(6)
    v_mfma_f32_16x16x32_bf16 v[16:19], v[112:115], v[80:83], v[16:19]
    buffer_load_dwordx4 v[100:103], v2, s[20:23], s80 offen offset:2048 nt
    s_waitcnt vmcnt(6)
    v_mfma_f32_16x16x32_bf16 v[16:19], v[116:119], v[84:87], v[16:19]
    buffer_load_dwordx4 v[104:107], v2, s[20:23], s80 offen offset:2304 nt
    s_add_u32 s53, s76, 14
    s_and_b32 s53, s53, 15
    s_mul_i32 s53, s53, 896
    buffer_load_dwordx4 a[236:239], v5, s[32:35], s53 offen offset:672
    s_waitcnt vmcnt(7)
    v_mfma_f32_16x16x32_bf16 v[16:19], v[120:123], v[88:91], v[16:19]
    s_add_u32 s53, s80, 16384
    buffer_load_dwordx4 v[108:111], v2, s[20:23], s53 offen offset:0 nt
    s_nop 7
    v_mov_b32_dpp v13, v16 quad_perm:[0,0,0,0] row_mask:0xf bank_mask:0xf
    v_mov_b32_dpp v14, v18 quad_perm:[2,2,2,2] row_mask:0xf bank_mask:0xf
    s_nop 0
    v_add_f32_dpp v13, v17, v13 quad_perm:[1,1,1,1] row_mask:0xf bank_mask:0xf
    v_add_f32_dpp v14, v19, v14 quad_perm:[3,3,3,3] row_mask:0xf bank_mask:0xf
    v_add_f32 v13, v13, v14
    ds_write_b32 v7, v13 offset:6400
    v_max_f32 v8, v8, v13
    s_mov_b32 s52, s80
    s_add_u32 s80, s80, 32768
    s_and_b32 s80, s80, 0xfffff
    s_waitcnt vmcnt(6)
    v_mfma_f32_16x16x32_bf16 v[16:19], v[92:95], v[60:63], 0
    s_add_u32 s53, s52, 16384
    buffer_load_dwordx4 v[112:115], v2, s[20:23], s53 offen offset:256 nt
    s_add_u32 s53, s52, 16384
    buffer_load_dwordx4 v[116:119], v2, s[20:23], s53 offen offset:2048 nt
    s_waitcnt vmcnt(7)
    v_mfma_f32_16x16x32_bf16 v[16:19], v[96:99], v[64:67], v[16:19]
    s_add_u32 s53, s52, 16384
    buffer_load_dwordx4 v[120:123], v2, s[20:23], s53 offen offset:2304 nt
    s_add_u32 s53, s76, 15
    s_and_b32 s53, s53, 15
    s_mul_i32 s53, s53, 896
    buffer_load_dwordx4 a[240:243], v5, s[32:35], s53 offen offset:0
    s_waitcnt vmcnt(7)
    v_mfma_f32_16x16x32_bf16 v[16:19], v[100:103], v[68:71], v[16:19]
    buffer_load_dwordx4 v[92:95], v2, s[20:23], s80 offen offset:0 nt
    s_waitcnt vmcnt(7)
    v_mfma_f32_16x16x32_bf16 v[16:19], v[104:107], v[72:75], v[16:19]
    buffer_load_dwordx4 v[96:99], v2, s[20:23], s80 offen offset:256 nt
    s_waitcnt vmcnt(6)
    v_mfma_f32_16x16x32_bf16 v[16:19], v[108:111], v[76:79], v[16:19]
    s_add_u32 s53, s76, 15
    s_and_b32 s53, s53, 15
    s_mul_i32 s53, s53, 896
    buffer_load_dwordx4 a[244:247], v5, s[32:35], s53 offen offset:224
    s_waitcnt vmcnt(6)
    v_mfma_f32_16x16x32_bf16 v[16:19], v[112:115], v[80:83], v[16:19]
    buffer_load_dwordx4 v[100:103], v2, s[20:23], s80 offen offset:2048 nt
    s_waitcnt vmcnt(6)
    v_mfma_f32_16x16x32_bf16 v[16:19], v[116:119], v[84:87], v[16:19]
    buffer_load_dwordx4 v[104:107], v2, s[20:23], s80 offen offset:2304 nt
    s_add_u32 s53, s76, 15
    s_and_b32 s53, s53, 15
    s_mul_i32 s53, s53, 896
    buffer_load_dwordx4 a[248:251], v5, s[32:35], s53 offen offset:448
    s_waitcnt vmcnt(7)
    v_mfma_f32_16x16x32_bf16 v[16:19], v[120:123], v[88:91], v[16:19]
    s_add_u32 s53, s80, 16384
    buffer_load_dwordx4 v[108:111], v2, s[20:23], s53 offen offset:0 nt
    s_nop 7
    v_mov_b32_dpp v13, v16 quad_perm:[0,0,0,0] row_mask:0xf bank_mask:0xf
    v_mov_b32_dpp v14, v18 quad_perm:[2,2,2,2] row_mask:0xf bank_mask:0xf
    s_nop 0
    v_add_f32_dpp v13, v17, v13 quad_perm:[1,1,1,1] row_mask:0xf bank_mask:0xf
    v_add_f32_dpp v14, v19, v14 quad_perm:[3,3,3,3] row_mask:0xf bank_mask:0xf
    v_add_f32 v13, v13, v14
    ds_write_b32 v7, v13 offset:6656
    v_max_f32 v8, v8, v13
    s_mov_b32 s52, s80
    s_add_u32 s80, s80, 32768
    s_and_b32 s80, s80, 0xfffff
    s_waitcnt vmcnt(6)
    v_mfma_f32_16x16x32_bf16 v[16:19], v[92:95], v[60:63], 0
    s_add_u32 s53, s52, 16384
    buffer_load_dwordx4 v[112:115], v2, s[20:23], s53 offen offset:256 nt
    s_add_u32 s53, s52, 16384
    buffer_load_dwordx4 v[116:119], v2, s[20:23], s53 offen offset:2048 nt
    s_waitcnt vmcnt(7)
    v_mfma_f32_16x16x32_bf16 v[16:19], v[96:99], v[64:67], v[16:19]
    s_add_u32 s53, s52, 16384
    buffer_load_dwordx4 v[120:123], v2, s[20:23], s53 offen offset:2304 nt
    s_add_u32 s53, s76, 15
    s_and_b32 s53, s53, 15
    s_mul_i32 s53, s53, 896
    buffer_load_dwordx4 a[252:255], v5, s[32:35], s53 offen offset:672
    s_waitcnt vmcnt(7)
    v_mfma_f32_16x16x32_bf16 v[16:19], v[100:103], v[68:71], v[16:19]
    buffer_load_dwordx4 v[92:95], v2, s[20:23], s80 offen offset:0 nt
    s_waitcnt vmcnt(7)
    v_mfma_f32_16x16x32_bf16 v[16:19], v[104:107], v[72:75], v[16:19]
    buffer_load_dwordx4 v[96:99], v2, s[20:23], s80 offen offset:256 nt
    s_waitcnt vmcnt(6)
    v_mfma_f32_16x16x32_bf16 v[16:19], v[108:111], v[76:79], v[16:19]
    s_waitcnt vmcnt(5)
    v_mfma_f32_16x16x32_bf16 v[16:19], v[112:115], v[80:83], v[16:19]
    buffer_load_dwordx4 v[100:103], v2, s[20:23], s80 offen offset:2048 nt
    s_waitcnt vmcnt(5)
    v_mfma_f32_16x16x32_bf16 v[16:19], v[116:119], v[84:87], v[16:19]
    buffer_load_dwordx4 v[104:107], v2, s[20:23], s80 offen offset:2304 nt
    s_waitcnt vmcnt(5)
    v_mfma_f32_16x16x32_bf16 v[16:19], v[120:123], v[88:91], v[16:19]
    s_add_u32 s53, s80, 16384
    buffer_load_dwordx4 v[108:111], v2, s[20:23], s53 offen offset:0 nt
    s_nop 7
    v_mov_b32_dpp v13, v16 quad_perm:[0,0,0,0] row_mask:0xf bank_mask:0xf
    v_mov_b32_dpp v14, v18 quad_perm:[2,2,2,2] row_mask:0xf bank_mask:0xf
    s_nop 0
    v_add_f32_dpp v13, v17, v13 quad_perm:[1,1,1,1] row_mask:0xf bank_mask:0xf
    v_add_f32_dpp v14, v19, v14 quad_perm:[3,3,3,3] row_mask:0xf bank_mask:0xf
    v_add_f32 v13, v13, v14
    ds_write_b32 v7, v13 offset:6912
    v_max_f32 v8, v8, v13
    s_mov_b32 s52, s80
    s_add_u32 s80, s80, 32768
    s_and_b32 s80, s80, 0xfffff
    s_waitcnt vmcnt(4)
    v_mfma_f32_16x16x32_bf16 v[16:19], v[92:95], v[60:63], 0
    s_add_u32 s53, s52, 16384
    buffer_load_dwordx4 v[112:115], v2, s[20:23], s53 offen offset:256 nt
    s_add_u32 s53, s52, 16384
    buffer_load_dwordx4 v[116:119], v2, s[20:23], s53 offen offset:2048 nt
    s_waitcnt vmcnt(5)
    v_mfma_f32_16x16x32_bf16 v[16:19], v[96:99], v[64:67], v[16:19]
    s_add_u32 s53, s52, 16384
    buffer_load_dwordx4 v[120:123], v2, s[20:23], s53 offen offset:2304 nt
    s_waitcnt vmcnt(5)
    v_mfma_f32_16x16x32_bf16 v[16:19], v[100:103], v[68:71], v[16:19]
    buffer_load_dwordx4 v[92:95], v2, s[20:23], s80 offen offset:0 nt
    s_waitcnt vmcnt(5)
    v_mfma_f32_16x16x32_bf16 v[16:19], v[104:107], v[72:75], v[16:19]
    buffer_load_dwordx4 v[96:99], v2, s[20:23], s80 offen offset:256 nt
    s_waitcnt vmcnt(5)
    v_mfma_f32_16x16x32_bf16 v[16:19], v[108:111], v[76:79], v[16:19]
    s_waitcnt vmcnt(4)
    v_mfma_f32_16x16x32_bf16 v[16:19], v[112:115], v[80:83], v[16:19]
    buffer_load_dwordx4 v[100:103], v2, s[20:23], s80 offen offset:2048 nt
    s_waitcnt vmcnt(4)
    v_mfma_f32_16x16x32_bf16 v[16:19], v[116:119], v[84:87], v[16:19]
    buffer_load_dwordx4 v[104:107], v2, s[20:23], s80 offen offset:2304 nt
    s_waitcnt vmcnt(4)
    v_mfma_f32_16x16x32_bf16 v[16:19], v[120:123], v[88:91], v[16:19]
    s_add_u32 s53, s80, 16384
    buffer_load_dwordx4 v[108:111], v2, s[20:23], s53 offen offset:0 nt
    s_nop 7
    v_mov_b32_dpp v13, v16 quad_perm:[0,0,0,0] row_mask:0xf bank_mask:0xf
    v_mov_b32_dpp v14, v18 quad_perm:[2,2,2,2] row_mask:0xf bank_mask:0xf
    s_nop 0
    v_add_f32_dpp v13, v17, v13 quad_perm:[1,1,1,1] row_mask:0xf bank_mask:0xf
    v_add_f32_dpp v14, v19, v14 quad_perm:[3,3,3,3] row_mask:0xf bank_mask:0xf
    v_add_f32 v13, v13, v14
    ds_write_b32 v7, v13 offset:7168
    v_max_f32 v8, v8, v13
    s_mov_b32 s52, s80
    s_add_u32 s80, s80, 32768
    s_and_b32 s80, s80, 0xfffff
    v_add_u32 v7, 7424, v7
    s_mov_b32 s54, 2
L_kloop:
    s_waitcnt vmcnt(4)
    v_mfma_f32_16x16x32_bf16 v[16:19], v[92:95], v[60:63], 0
    s_add_u32 s53, s52, 16384
    buffer_load_dwordx4 v[112:115], v2, s[20:23], s53 offen offset:256 nt
    s_add_u32 s53, s52, 16384
    buffer_load_dwordx4 v[116:119], v2, s[20:23], s53 offen offset:2048 nt
    s_waitcnt vmcnt(5)
    v_mfma_f32_16x16x32_bf16 v[16:19], v[96:99], v[64:67], v[16:19]
    s_add_u32 s53, s52, 16384
    buffer_load_dwordx4 v[120:123], v2, s[20:23], s53 offen offset:2304 nt
    s_waitcnt vmcnt(5)
    v_mfma_f32_16x16x32_bf16 v[16:19], v[100:103], v[68:71], v[16:19]
    buffer_load_dwordx4 v[92:95], v2, s[20:23], s80 offen offset:0 nt
    s_waitcnt vmcnt(5)
    v_mfma_f32_16x16x32_bf16 v[16:19], v[104:107], v[72:75], v[16:19]
    buffer_load_dwordx4 v[96:99], v2, s[20:23], s80 offen offset:256 nt
    s_waitcnt vmcnt(5)
    v_mfma_f32_16x16x32_bf16 v[16:19], v[108:111], v[76:79], v[16:19]
    s_waitcnt vmcnt(4)
    v_mfma_f32_16x16x32_bf16 v[16:19], v[112:115], v[80:83], v[16:19]
    buffer_load_dwordx4 v[100:103], v2, s[20:23], s80 offen offset:2048 nt
    s_waitcnt vmcnt(4)
    v_mfma_f32_16x16x32_bf16 v[16:19], v[116:119], v[84:87], v[16:19]
    buffer_load_dwordx4 v[104:107], v2, s[20:23], s80 offen offset:2304 nt
    s_waitcnt vmcnt(4)
    v_mfma_f32_16x16x32_bf16 v[16:19], v[120:123], v[88:91], v[16:19]
    s_add_u32 s53, s80, 16384
    buffer_load_dwordx4 v[108:111], v2, s[20:23], s53 offen offset:0 nt
    s_nop 7
    v_mov_b32_dpp v13, v16 quad_perm:[0,0,0,0] row_mask:0xf bank_mask:0xf
    v_mov_b32_dpp v14, v18 quad_perm:[2,2,2,2] row_mask:0xf bank_mask:0xf
    s_nop 0
    v_add_f32_dpp v13, v17, v13 quad_perm:[1,1,1,1] row_mask:0xf bank_mask:0xf
    v_add_f32_dpp v14, v19, v14 quad_perm:[3,3,3,3] row_mask:0xf bank_mask:0xf
    v_add_f32 v13, v13, v14
    ds_write_b32 v7, v13 offset:0
    v_max_f32 v8, v8, v13
    v_add_u32 v7, 256, v7
    s_mov_b32 s52, s80
    s_add_u32 s80, s80, 32768
    s_and_b32 s80, s80, 0xfffff
    s_sub_u32 s54, s54, 1
    s_cmp_lg_u32 s54, 0
    s_cbranch_scc1 L_kloop
    s_waitcnt vmcnt(4)
    v_mfma_f32_16x16x32_bf16 v[16:19], v[92:95], v[60:63], 0
    s_add_u32 s53, s52, 16384
    buffer_load_dwordx4 v[112:115], v2, s[20:23], s53 offen offset:256 nt
    s_add_u32 s53, s52, 16384
    buffer_load_dwordx4 v[116:119], v2, s[20:23], s53 offen offset:2048 nt
    s_waitcnt vmcnt(5)
    v_mfma_f32_16x16x32_bf16 v[16:19], v[96:99], v[64:67], v[16:19]
    s_add_u32 s53, s52, 16384
    buffer_load_dwordx4 v[120:123], v2, s[20:23], s53 offen offset:2304 nt
    s_waitcnt vmcnt(5)
    v_mfma_f32_16x16x32_bf16 v[16:19], v[100:103], v[68:71], v[16:19]
    s_add_u32 s53, s81, 0
    s_and_b32 s53, s53, 0xfffff
    buffer_load_dwordx4 v[92:95], v3, s[24:27], s53 offen offset:0 nt
    s_waitcnt vmcnt(5)
    v_mfma_f32_16x16x32_bf16 v[16:19], v[104:107], v[72:75], v[16:19]
    s_add_u32 s53, s81, 0
    s_and_b32 s53, s53, 0xfffff
    buffer_load_dwordx4 v[96:99], v3, s[24:27], s53 offen offset:256 nt
    s_waitcnt vmcnt(5)
    v_mfma_f32_16x16x32_bf16 v[16:19], v[108:111], v[76:79], v[16:19]
    s_waitcnt vmcnt(4)
    v_mfma_f32_16x16x32_bf16 v[16:19], v[112:115], v[80:83], v[16:19]
    s_add_u32 s53, s81, 0
    s_and_b32 s53, s53, 0xfffff
    buffer_load_dwordx4 v[100:103], v3, s[24:27], s53 offen offset:2048 nt
    s_waitcnt vmcnt(4)
    v_mfma_f32_16x16x32_bf16 v[16:19], v[116:119], v[84:87], v[16:19]
    s_add_u32 s53, s81, 0
    s_and_b32 s53, s53, 0xfffff
    buffer_load_dwordx4 v[104:107], v3, s[24:27], s53 offen offset:2304 nt
    s_waitcnt vmcnt(4)
    v_mfma_f32_16x16x32_bf16 v[16:19], v[120:123], v[88:91], v[16:19]
    s_add_u32 s53, s81, 16384
    s_and_b32 s53, s53, 0xfffff
    buffer_load_dwordx4 v[108:111], v3, s[24:27], s53 offen offset:0 nt
    s_nop 7
    v_mov_b32_dpp v13, v16 quad_perm:[0,0,0,0] row_mask:0xf bank_mask:0xf
    v_mov_b32_dpp v14, v18 quad_perm:[2,2,2,2] row_mask:0xf bank_mask:0xf
    s_nop 0
    v_add_f32_dpp v13, v17, v13 quad_perm:[1,1,1,1] row_mask:0xf bank_mask:0xf
    v_add_f32_dpp v14, v19, v14 quad_perm:[3,3,3,3] row_mask:0xf bank_mask:0xf
    v_add_f32 v13, v13, v14
    ds_write_b32 v7, v13 offset:0
    v_max_f32 v8, v8, v13
    v_mov_b32 v7, v12
    s_nop 1
    v_max_f32_dpp v8, v8, v8 row_ror:4 row_mask:0xf bank_mask:0xf
    s_nop 1
    v_max_f32_dpp v8, v8, v8 row_ror:8 row_mask:0xf bank_mask:0xf
    s_nop 1
    v_max_f32_dpp v8, v8, v8 row_bcast:15 row_mask:0xa bank_mask:0xf
    s_nop 1
    v_max_f32_dpp v8, v8, v8 row_bcast:31 row_mask:0xc bank_mask:0xf
    s_lshl_b32 s53, s3, 2
    v_mov_b32 v13, s53
    s_mov_b32 exec_lo, 0
    s_mov_b32 exec_hi, 0x80000000
    ds_write_b32 v13, v8 offset:4608
    s_mov_b64 exec, -1
    v_mov_b32 v13, 0
    s_waitcnt lgkmcnt(0)
    s_barrier
    ds_read_b128 v[220:223], v13 offset:4608
    ds_read_b32 v10, v7
    s_waitcnt lgkmcnt(0)
    v_max3_f32 v8, v220, v221, v222
    v_max_f32 v8, v8, v223
    v_mul_f32 v15, s55, v8
    v_sub_f32 v15, 0, v15
    s_add_u32 s52, s81, 0
    s_and_b32 s52, s52, 0xfffff
    s_add_u32 s80, s52, 32768
    s_and_b32 s80, s80, 0xfffff
    v_mov_b32 v16, 0
    v_mov_b32 v17, 0
    v_mov_b32 v18, 0
    v_mov_b32 v19, 0
    v_mov_b32 v20, 0
    v_mov_b32 v21, 0
    v_mov_b32 v22, 0
    v_mov_b32 v23, 0
    s_mov_b32 s54, 27
L_vloop:
    s_waitcnt lgkmcnt(0)
    v_fma_f32 v11, v10, s55, v15
    ds_read_b32 v10, v7 offset:256
    v_exp_f32 v11, v11
    s_nop 0
    v_cvt_pk_bf16_f32 v12, v11, v11
    v_add_f32 v9, v9, v11
    s_nop 0
    v_and_b32_dpp v36, v12, v24 row_newbcast:0 row_mask:0xf bank_mask:0xf
    v_and_b32_dpp v37, v12, v25 row_newbcast:0 row_mask:0xf bank_mask:0xf
    v_and_b32_dpp v38, v12, v26 row_newbcast:0 row_mask:0xf bank_mask:0xf
    v_and_b32_dpp v39, v12, v27 row_newbcast:0 row_mask:0xf bank_mask:0xf
    s_nop 0
    s_waitcnt vmcnt(4)
    v_mfma_f32_16x16x32_bf16 v[16:19], v[92:95], v[36:39], v[16:19]
    s_add_u32 s53, s52, 16384
    buffer_load_dwordx4 v[112:115], v3, s[24:27], s53 offen offset:256 nt
    s_add_u32 s53, s52, 16384
    buffer_load_dwordx4 v[116:119], v3, s[24:27], s53 offen offset:2048 nt
    v_and_b32_dpp v40, v12, v24 row_newbcast:4 row_mask:0xf bank_mask:0xf
    v_and_b32_dpp v41, v12, v25 row_newbcast:4 row_mask:0xf bank_mask:0xf
    v_and_b32_dpp v42, v12, v26 row_newbcast:4 row_mask:0xf bank_mask:0xf
    v_and_b32_dpp v43, v12, v27 row_newbcast:4 row_mask:0xf bank_mask:0xf
    s_waitcnt vmcnt(5)
    v_mfma_f32_16x16x32_bf16 v[20:23], v[96:99], v[36:39], v[20:23]
    s_add_u32 s53, s52, 16384
    buffer_load_dwordx4 v[120:123], v3, s[24:27], s53 offen offset:2304 nt
    s_waitcnt vmcnt(5)
    v_mfma_f32_16x16x32_bf16 v[16:19], v[100:103], v[40:43], v[16:19]
    buffer_load_dwordx4 v[92:95], v3, s[24:27], s80 offen offset:0 nt
    v_and_b32_dpp v36, v12, v24 row_newbcast:8 row_mask:0xf bank_mask:0xf
    v_and_b32_dpp v37, v12, v25 row_newbcast:8 row_mask:0xf bank_mask:0xf
    v_and_b32_dpp v38, v12, v26 row_newbcast:8 row_mask:0xf bank_mask:0xf
    v_and_b32_dpp v39, v12, v27 row_newbcast:8 row_mask:0xf bank_mask:0xf
    s_waitcnt vmcnt(5)
    v_mfma_f32_16x16x32_bf16 v[20:23], v[104:107], v[40:43], v[20:23]
    buffer_load_dwordx4 v[96:99], v3, s[24:27], s80 offen offset:256 nt
    s_waitcnt vmcnt(5)
    v_mfma_f32_16x16x32_bf16 v[16:19], v[108:111], v[36:39], v[16:19]
    v_and_b32_dpp v40, v12, v24 row_newbcast:12 row_mask:0xf bank_mask:0xf
    v_and_b32_dpp v41, v12, v25 row_newbcast:12 row_mask:0xf bank_mask:0xf
    v_and_b32_dpp v42, v12, v26 row_newbcast:12 row_mask:0xf bank_mask:0xf
    v_and_b32_dpp v43, v12, v27 row_newbcast:12 row_mask:0xf bank_mask:0xf
    s_waitcnt vmcnt(4)
    v_mfma_f32_16x16x32_bf16 v[20:23], v[112:115], v[36:39], v[20:23]
    buffer_load_dwordx4 v[100:103], v3, s[24:27], s80 offen offset:2048 nt
    s_waitcnt vmcnt(4)
    v_mfma_f32_16x16x32_bf16 v[16:19], v[116:119], v[40:43], v[16:19]
    buffer_load_dwordx4 v[104:107], v3, s[24:27], s80 offen offset:2304 nt
    s_waitcnt vmcnt(4)
    v_mfma_f32_16x16x32_bf16 v[20:23], v[120:123], v[40:43], v[20:23]
    s_add_u32 s53, s80, 16384
    buffer_load_dwordx4 v[108:111], v3, s[24:27], s53 offen offset:0 nt
    v_add_u32 v7, 256, v7
    s_mov_b32 s52, s80
    s_add_u32 s80, s80, 32768
    s_and_b32 s80, s80, 0xfffff
    s_sub_u32 s54, s54, 1
    s_cmp_lg_u32 s54, 0
    s_cbranch_scc1 L_vloop
    s_waitcnt lgkmcnt(0)
    v_fma_f32 v11, v10, s55, v15
    ds_read_b32 v10, v7 offset:256
    v_exp_f32 v11, v11
    s_nop 0
    v_cvt_pk_bf16_f32 v12, v11, v11
    v_add_f32 v9, v9, v11
    s_nop 0
    v_and_b32_dpp v36, v12, v24 row_newbcast:0 row_mask:0xf bank_mask:0xf
    v_and_b32_dpp v37, v12, v25 row_newbcast:0 row_mask:0xf bank_mask:0xf
    v_and_b32_dpp v38, v12, v26 row_newbcast:0 row_mask:0xf bank_mask:0xf
    v_and_b32_dpp v39, v12, v27 row_newbcast:0 row_mask:0xf bank_mask:0xf
    s_nop 0
    s_waitcnt vmcnt(4)
    v_mfma_f32_16x16x32_bf16 v[16:19], v[92:95], v[36:39], v[16:19]
    s_add_u32 s53, s52, 16384
    buffer_load_dwordx4 v[112:115], v3, s[24:27], s53 offen offset:256 nt
    s_add_u32 s53, s52, 16384
    buffer_load_dwordx4 v[116:119], v3, s[24:27], s53 offen offset:2048 nt
    s_add_u32 s53, s52, 16384
    buffer_load_dwordx4 v[120:123], v3, s[24:27], s53 offen offset:2304 nt
    buffer_load_dwordx4 v[92:95], v3, s[24:27], s80 offen offset:0 nt
    v_and_b32_dpp v40, v12, v24 row_newbcast:4 row_mask:0xf bank_mask:0xf
    v_and_b32_dpp v41, v12, v25 row_newbcast:4 row_mask:0xf bank_mask:0xf
    v_and_b32_dpp v42, v12, v26 row_newbcast:4 row_mask:0xf bank_mask:0xf
    v_and_b32_dpp v43, v12, v27 row_newbcast:4 row_mask:0xf bank_mask:0xf
    s_waitcnt vmcnt(7)
    v_mfma_f32_16x16x32_bf16 v[20:23], v[96:99], v[36:39], v[20:23]
    buffer_load_dwordx4 v[96:99], v3, s[24:27], s80 offen offset:256 nt
    s_waitcnt vmcnt(7)
    v_mfma_f32_16x16x32_bf16 v[16:19], v[100:103], v[40:43], v[16:19]
    buffer_load_dwordx4 v[100:103], v3, s[24:27], s80 offen offset:2048 nt
    v_and_b32_dpp v36, v12, v24 row_newbcast:8 row_mask:0xf bank_mask:0xf
    v_and_b32_dpp v37, v12, v25 row_newbcast:8 row_mask:0xf bank_mask:0xf
    v_and_b32_dpp v38, v12, v26 row_newbcast:8 row_mask:0xf bank_mask:0xf
    v_and_b32_dpp v39, v12, v27 row_newbcast:8 row_mask:0xf bank_mask:0xf
    s_waitcnt vmcnt(7)
    v_mfma_f32_16x16x32_bf16 v[20:23], v[104:107], v[40:43], v[20:23]
    buffer_load_dwordx4 v[104:107], v3, s[24:27], s80 offen offset:2304 nt
    s_waitcnt vmcnt(7)
    v_mfma_f32_16x16x32_bf16 v[16:19], v[108:111], v[36:39], v[16:19]
    s_add_u32 s53, s80, 16384
    buffer_load_dwordx4 v[108:111], v3, s[24:27], s53 offen offset:0 nt
    v_and_b32_dpp v40, v12, v24 row_newbcast:12 row_mask:0xf bank_mask:0xf
    v_and_b32_dpp v41, v12, v25 row_newbcast:12 row_mask:0xf bank_mask:0xf
    v_and_b32_dpp v42, v12, v26 row_newbcast:12 row_mask:0xf bank_mask:0xf
    v_and_b32_dpp v43, v12, v27 row_newbcast:12 row_mask:0xf bank_mask:0xf
    s_waitcnt vmcnt(7)
    v_mfma_f32_16x16x32_bf16 v[20:23], v[112:115], v[36:39], v[20:23]
    s_add_u32 s53, s80, 16384
    buffer_load_dwordx4 v[112:115], v3, s[24:27], s53 offen offset:256 nt
    s_waitcnt vmcnt(7)
    v_mfma_f32_16x16x32_bf16 v[16:19], v[116:119], v[40:43], v[16:19]
    s_add_u32 s53, s80, 16384
    buffer_load_dwordx4 v[116:119], v3, s[24:27], s53 offen offset:2048 nt
    s_waitcnt vmcnt(7)
    v_mfma_f32_16x16x32_bf16 v[20:23], v[120:123], v[40:43], v[20:23]
    s_add_u32 s53, s80, 16384
    buffer_load_dwordx4 v[120:123], v3, s[24:27], s53 offen offset:2304 nt
    v_add_u32 v7, 256, v7
    s_mov_b32 s52, s80
    s_add_u32 s80, s80, 32768
    s_and_b32 s80, s80, 0xfffff
    s_waitcnt lgkmcnt(0)
    v_fma_f32 v11, v10, s55, v15
    ds_read_b32 v10, v7 offset:256
    v_exp_f32 v11, v11
    s_nop 0
    v_cvt_pk_bf16_f32 v12, v11, v11
    v_add_f32 v9, v9, v11
    s_nop 0
    v_and_b32_dpp v36, v12, v24 row_newbcast:0 row_mask:0xf bank_mask:0xf
    v_and_b32_dpp v37, v12, v25 row_newbcast:0 row_mask:0xf bank_mask:0xf
    v_and_b32_dpp v38, v12, v26 row_newbcast:0 row_mask:0xf bank_mask:0xf
    v_and_b32_dpp v39, v12, v27 row_newbcast:0 row_mask:0xf bank_mask:0xf
    s_nop 0
    s_waitcnt vmcnt(7)
    v_mfma_f32_16x16x32_bf16 v[16:19], v[92:95], v[36:39], v[16:19]
    buffer_load_dwordx4 v[92:95], v3, s[24:27], s80 offen offset:0 nt
    v_and_b32_dpp v40, v12, v24 row_newbcast:4 row_mask:0xf bank_mask:0xf
    v_and_b32_dpp v41, v12, v25 row_newbcast:4 row_mask:0xf bank_mask:0xf
    v_and_b32_dpp v42, v12, v26 row_newbcast:4 row_mask:0xf bank_mask:0xf
    v_and_b32_dpp v43, v12, v27 row_newbcast:4 row_mask:0xf bank_mask:0xf
    s_waitcnt vmcnt(7)
    v_mfma_f32_16x16x32_bf16 v[20:23], v[96:99], v[36:39], v[20:23]
    buffer_load_dwordx4 v[96:99], v3, s[24:27], s80 offen offset:256 nt
    s_waitcnt vmcnt(7)
    v_mfma_f32_16x16x32_bf16 v[16:19], v[100:103], v[40:43], v[16:19]
    buffer_load_dwordx4 v[100:103], v3, s[24:27], s80 offen offset:2048 nt
    v_and_b32_dpp v36, v12, v24 row_newbcast:8 row_mask:0xf bank_mask:0xf
    v_and_b32_dpp v37, v12, v25 row_newbcast:8 row_mask:0xf bank_mask:0xf
    v_and_b32_dpp v38, v12, v26 row_newbcast:8 row_mask:0xf bank_mask:0xf
    v_and_b32_dpp v39, v12, v27 row_newbcast:8 row_mask:0xf bank_mask:0xf
    s_waitcnt vmcnt(7)
    v_mfma_f32_16x16x32_bf16 v[20:23], v[104:107], v[40:43], v[20:23]
    buffer_load_dwordx4 v[104:107], v3, s[24:27], s80 offen offset:2304 nt
    s_waitcnt vmcnt(7)
    v_mfma_f32_16x16x32_bf16 v[16:19], v[108:111], v[36:39], v[16:19]
    s_add_u32 s53, s80, 16384
    buffer_load_dwordx4 v[108:111], v3, s[24:27], s53 offen offset:0 nt
    v_and_b32_dpp v40, v12, v24 row_newbcast:12 row_mask:0xf bank_mask:0xf
    v_and_b32_dpp v41, v12, v25 row_newbcast:12 row_mask:0xf bank_mask:0xf
    v_and_b32_dpp v42, v12, v26 row_newbcast:12 row_mask:0xf bank_mask:0xf
    v_and_b32_dpp v43, v12, v27 row_newbcast:12 row_mask:0xf bank_mask:0xf
    s_waitcnt vmcnt(7)
    v_mfma_f32_16x16x32_bf16 v[20:23], v[112:115], v[36:39], v[20:23]
    s_add_u32 s53, s80, 16384
    buffer_load_dwordx4 v[112:115], v3, s[24:27], s53 offen offset:256 nt
    s_waitcnt vmcnt(7)
    v_mfma_f32_16x16x32_bf16 v[16:19], v[116:119], v[40:43], v[16:19]
    s_add_u32 s53, s80, 16384
    buffer_load_dwordx4 v[116:119], v3, s[24:27], s53 offen offset:2048 nt
    s_waitcnt vmcnt(7)
    v_mfma_f32_16x16x32_bf16 v[20:23], v[120:123], v[40:43], v[20:23]
    s_add_u32 s53, s80, 16384
    buffer_load_dwordx4 v[120:123], v3, s[24:27], s53 offen offset:2304 nt
    v_add_u32 v7, 256, v7
    s_mov_b32 s52, s80
    s_add_u32 s80, s80, 32768
    s_and_b32 s80, s80, 0xfffff
    s_waitcnt lgkmcnt(0)
    v_fma_f32 v11, v10, s55, v15
    ds_read_b32 v10, v7 offset:256
    v_exp_f32 v11, v11
    s_nop 0
    v_cvt_pk_bf16_f32 v12, v11, v11
    v_add_f32 v9, v9, v11
    s_nop 0
    v_and_b32_dpp v36, v12, v24 row_newbcast:0 row_mask:0xf bank_mask:0xf
    v_and_b32_dpp v37, v12, v25 row_newbcast:0 row_mask:0xf bank_mask:0xf
    v_and_b32_dpp v38, v12, v26 row_newbcast:0 row_mask:0xf bank_mask:0xf
    v_and_b32_dpp v39, v12, v27 row_newbcast:0 row_mask:0xf bank_mask:0xf
    s_nop 0
    s_waitcnt vmcnt(7)
    v_mfma_f32_16x16x32_bf16 v[16:19], v[92:95], v[36:39], v[16:19]
    buffer_load_dwordx4 v[92:95], v3, s[24:27], s80 offen offset:0 nt
    v_and_b32_dpp v40, v12, v24 row_newbcast:4 row_mask:0xf bank_mask:0xf
    v_and_b32_dpp v41, v12, v25 row_newbcast:4 row_mask:0xf bank_mask:0xf
    v_and_b32_dpp v42, v12, v26 row_newbcast:4 row_mask:0xf bank_mask:0xf
    v_and_b32_dpp v43, v12, v27 row_newbcast:4 row_mask:0xf bank_mask:0xf
    s_waitcnt vmcnt(7)
    v_mfma_f32_16x16x32_bf16 v[20:23], v[96:99], v[36:39], v[20:23]
    buffer_load_dwordx4 v[96:99], v3, s[24:27], s80 offen offset:256 nt
    s_waitcnt vmcnt(7)
    v_mfma_f32_16x16x32_bf16 v[16:19], v[100:103], v[40:43], v[16:19]
    buffer_load_dwordx4 v[100:103], v3, s[24:27], s80 offen offset:2048 nt
    v_and_b32_dpp v36, v12, v24 row_newbcast:8 row_mask:0xf bank_mask:0xf
    v_and_b32_dpp v37, v12, v25 row_newbcast:8 row_mask:0xf bank_mask:0xf
    v_and_b32_dpp v38, v12, v26 row_newbcast:8 row_mask:0xf bank_mask:0xf
    v_and_b32_dpp v39, v12, v27 row_newbcast:8 row_mask:0xf bank_mask:0xf
    s_waitcnt vmcnt(7)
    v_mfma_f32_16x16x32_bf16 v[20:23], v[104:107], v[40:43], v[20:23]
    buffer_load_dwordx4 v[104:107], v3, s[24:27], s80 offen offset:2304 nt
    s_waitcnt vmcnt(7)
    v_mfma_f32_16x16x32_bf16 v[16:19], v[108:111], v[36:39], v[16:19]
    s_add_u32 s53, s80, 16384
    buffer_load_dwordx4 v[108:111], v3, s[24:27], s53 offen offset:0 nt
    v_and_b32_dpp v40, v12, v24 row_newbcast:12 row_mask:0xf bank_mask:0xf
    v_and_b32_dpp v41, v12, v25 row_newbcast:12 row_mask:0xf bank_mask:0xf
    v_and_b32_dpp v42, v12, v26 row_newbcast:12 row_mask:0xf bank_mask:0xf
    v_and_b32_dpp v43, v12, v27 row_newbcast:12 row_mask:0xf bank_mask:0xf
    s_waitcnt vmcnt(7)
    v_mfma_f32_16x16x32_bf16 v[20:23], v[112:115], v[36:39], v[20:23]
    s_add_u32 s53, s80, 16384
    buffer_load_dwordx4 v[112:115], v3, s[24:27], s53 offen offset:256 nt
    s_waitcnt vmcnt(7)
    v_mfma_f32_16x16x32_bf16 v[16:19], v[116:119], v[40:43], v[16:19]
    s_add_u32 s53, s80, 16384
    buffer_load_dwordx4 v[116:119], v3, s[24:27], s53 offen offset:2048 nt
    s_waitcnt vmcnt(7)
    v_mfma_f32_16x16x32_bf16 v[20:23], v[120:123], v[40:43], v[20:23]
    s_add_u32 s53, s80, 16384
    buffer_load_dwordx4 v[120:123], v3, s[24:27], s53 offen offset:2304 nt
    v_add_u32 v7, 256, v7
    s_mov_b32 s52, s80
    s_add_u32 s80, s80, 32768
    s_and_b32 s80, s80, 0xfffff
    s_waitcnt lgkmcnt(0)
    v_fma_f32 v11, v10, s55, v15
    ds_read_b32 v10, v7 offset:256
    v_exp_f32 v11, v11
    s_nop 0
    v_cvt_pk_bf16_f32 v12, v11, v11
    v_add_f32 v9, v9, v11
    s_nop 0
    v_and_b32_dpp v36, v12, v24 row_newbcast:0 row_mask:0xf bank_mask:0xf
    v_and_b32_dpp v37, v12, v25 row_newbcast:0 row_mask:0xf bank_mask:0xf
    v_and_b32_dpp v38, v12, v26 row_newbcast:0 row_mask:0xf bank_mask:0xf
    v_and_b32_dpp v39, v12, v27 row_newbcast:0 row_mask:0xf bank_mask:0xf
    s_nop 0
    s_waitcnt vmcnt(7)
    v_mfma_f32_16x16x32_bf16 v[16:19], v[92:95], v[36:39], v[16:19]
    buffer_load_dwordx4 v[92:95], v3, s[24:27], s80 offen offset:0 nt
    v_and_b32_dpp v40, v12, v24 row_newbcast:4 row_mask:0xf bank_mask:0xf
    v_and_b32_dpp v41, v12, v25 row_newbcast:4 row_mask:0xf bank_mask:0xf
    v_and_b32_dpp v42, v12, v26 row_newbcast:4 row_mask:0xf bank_mask:0xf
    v_and_b32_dpp v43, v12, v27 row_newbcast:4 row_mask:0xf bank_mask:0xf
    s_waitcnt vmcnt(7)
    v_mfma_f32_16x16x32_bf16 v[20:23], v[96:99], v[36:39], v[20:23]
    buffer_load_dwordx4 v[96:99], v3, s[24:27], s80 offen offset:256 nt
    s_waitcnt vmcnt(7)
    v_mfma_f32_16x16x32_bf16 v[16:19], v[100:103], v[40:43], v[16:19]
    buffer_load_dwordx4 v[100:103], v3, s[24:27], s80 offen offset:2048 nt
    v_and_b32_dpp v36, v12, v24 row_newbcast:8 row_mask:0xf bank_mask:0xf
    v_and_b32_dpp v37, v12, v25 row_newbcast:8 row_mask:0xf bank_mask:0xf
    v_and_b32_dpp v38, v12, v26 row_newbcast:8 row_mask:0xf bank_mask:0xf
    v_and_b32_dpp v39, v12, v27 row_newbcast:8 row_mask:0xf bank_mask:0xf
    s_waitcnt vmcnt(7)
    v_mfma_f32_16x16x32_bf16 v[20:23], v[104:107], v[40:43], v[20:23]
    buffer_load_dwordx4 v[104:107], v3, s[24:27], s80 offen offset:2304 nt
    s_waitcnt vmcnt(7)
    v_mfma_f32_16x16x32_bf16 v[16:19], v[108:111], v[36:39], v[16:19]
    s_add_u32 s53, s80, 16384
    buffer_load_dwordx4 v[108:111], v3, s[24:27], s53 offen offset:0 nt
    v_and_b32_dpp v40, v12, v24 row_newbcast:12 row_mask:0xf bank_mask:0xf
    v_and_b32_dpp v41, v12, v25 row_newbcast:12 row_mask:0xf bank_mask:0xf
    v_and_b32_dpp v42, v12, v26 row_newbcast:12 row_mask:0xf bank_mask:0xf
    v_and_b32_dpp v43, v12, v27 row_newbcast:12 row_mask:0xf bank_mask:0xf
    s_waitcnt vmcnt(7)
    v_mfma_f32_16x16x32_bf16 v[20:23], v[112:115], v[36:39], v[20:23]
    s_add_u32 s53, s80, 16384
    buffer_load_dwordx4 v[112:115], v3, s[24:27], s53 offen offset:256 nt
    s_waitcnt vmcnt(7)
    v_mfma_f32_16x16x32_bf16 v[16:19], v[116:119], v[40:43], v[16:19]
    s_add_u32 s53, s80, 16384
    buffer_load_dwordx4 v[116:119], v3, s[24:27], s53 offen offset:2048 nt
    s_waitcnt vmcnt(7)
    v_mfma_f32_16x16x32_bf16 v[20:23], v[120:123], v[40:43], v[20:23]
    s_add_u32 s53, s80, 16384
    buffer_load_dwordx4 v[120:123], v3, s[24:27], s53 offen offset:2304 nt
    v_add_u32 v7, 256, v7
    s_mov_b32 s52, s80
    s_add_u32 s80, s80, 32768
    s_and_b32 s80, s80, 0xfffff
    v_lshrrev_b32 v233, 4, v1
    v_lshlrev_b32 v233, 7, v233
    v_and_b32 v232, 15, v1
    v_lshl_add_u32 v233, v232, 2, v233
    s_lshl_b32 s53, s3, 10
    v_add_u32 v230, s53, v233
    s_lshl_b32 s53, s3, 11
    v_add_u32 v231, s53, v233
    v_add_u32 v232, s76, v0
    v_and_b32 v232, 15, v232
    v_and_or_b32 v232, v0, -16, v232
    v_lshlrev_b32 v232, 2, v232
    v_lshlrev_b32 v233, 3, v0
    s_waitcnt lgkmcnt(0)
    v_fma_f32 v11, v10, s55, v15
    v_exp_f32 v11, v11
    s_nop 0
    v_cvt_pk_bf16_f32 v12, v11, v11
    v_add_f32 v9, v9, v11
    s_nop 0
    v_and_b32_dpp v36, v12, v24 row_newbcast:0 row_mask:0xf bank_mask:0xf
    v_and_b32_dpp v37, v12, v25 row_newbcast:0 row_mask:0xf bank_mask:0xf
    v_and_b32_dpp v38, v12, v26 row_newbcast:0 row_mask:0xf bank_mask:0xf
    v_and_b32_dpp v39, v12, v27 row_newbcast:0 row_mask:0xf bank_mask:0xf
    s_nop 0
    s_waitcnt vmcnt(7)
    v_mfma_f32_16x16x32_bf16 v[16:19], v[92:95], v[36:39], v[16:19]
    v_and_b32_dpp v40, v12, v24 row_newbcast:4 row_mask:0xf bank_mask:0xf
    v_and_b32_dpp v41, v12, v25 row_newbcast:4 row_mask:0xf bank_mask:0xf
    v_and_b32_dpp v42, v12, v26 row_newbcast:4 row_mask:0xf bank_mask:0xf
    v_and_b32_dpp v43, v12, v27 row_newbcast:4 row_mask:0xf bank_mask:0xf
    s_waitcnt vmcnt(6)
    v_mfma_f32_16x16x32_bf16 v[20:23], v[96:99], v[36:39], v[20:23]
    s_waitcnt vmcnt(5)
    v_mfma_f32_16x16x32_bf16 v[16:19], v[100:103], v[40:43], v[16:19]
    v_and_b32_dpp v36, v12, v24 row_newbcast:8 row_mask:0xf bank_mask:0xf
    v_and_b32_dpp v37, v12, v25 row_newbcast:8 row_mask:0xf bank_mask:0xf
    v_and_b32_dpp v38, v12, v26 row_newbcast:8 row_mask:0xf bank_mask:0xf
    v_and_b32_dpp v39, v12, v27 row_newbcast:8 row_mask:0xf bank_mask:0xf
    s_waitcnt vmcnt(4)
    v_mfma_f32_16x16x32_bf16 v[20:23], v[104:107], v[40:43], v[20:23]
    s_waitcnt vmcnt(3)
    v_mfma_f32_16x16x32_bf16 v[16:19], v[108:111], v[36:39], v[16:19]
    v_and_b32_dpp v40, v12, v24 row_newbcast:12 row_mask:0xf bank_mask:0xf
    v_and_b32_dpp v41, v12, v25 row_newbcast:12 row_mask:0xf bank_mask:0xf
    v_and_b32_dpp v42, v12, v26 row_newbcast:12 row_mask:0xf bank_mask:0xf
    v_and_b32_dpp v43, v12, v27 row_newbcast:12 row_mask:0xf bank_mask:0xf
    s_waitcnt vmcnt(2)
    v_mfma_f32_16x16x32_bf16 v[20:23], v[112:115], v[36:39], v[20:23]
    s_waitcnt vmcnt(1)
    v_mfma_f32_16x16x32_bf16 v[16:19], v[116:119], v[40:43], v[16:19]
    s_waitcnt vmcnt(0)
    v_mfma_f32_16x16x32_bf16 v[20:23], v[120:123], v[40:43], v[20:23]
    s_cmp_lg_u32 s3, 0
    s_cbranch_scc1 L_tk
    s_mul_i32 s53, s49, 64
    v_mov_b32 v229, s53
    v_mov_b32 v228, 1
    s_mov_b64 exec, 1
    global_atomic_add v228, v229, v228, s[16:17] sc0
L_tk:
    s_mov_b32 exec_lo, 0x00ff00ff
    s_mov_b32 exec_hi, 0x00ff00ff
    s_nop 3
    ds_write_b32 v230, v16 offset:0
    ds_write_b32 v230, v17 offset:32
    ds_write_b32 v230, v18 offset:64
    ds_write_b32 v230, v19 offset:96
    ds_write_b32 v230, v20 offset:512
    ds_write_b32 v230, v21 offset:544
    ds_write_b32 v230, v22 offset:576
    ds_write_b32 v230, v23 offset:608
    s_mov_b64 exec, -1
    v_add_f32_dpp v9, v9, v9 row_ror:4 row_mask:0xf bank_mask:0xf
    s_nop 1
    v_add_f32_dpp v9, v9, v9 row_ror:8 row_mask:0xf bank_mask:0xf
    s_nop 1
    v_add_f32_dpp v9, v9, v9 row_bcast:15 row_mask:0xa bank_mask:0xf
    s_nop 1
    v_add_f32_dpp v9, v9, v9 row_bcast:31 row_mask:0xc bank_mask:0xf
    s_nop 1
    s_lshl_b32 s53, s3, 2
    v_mov_b32 v13, s53
    s_mov_b32 exec_lo, 0
    s_mov_b32 exec_hi, 0x80000000
    ds_write_b32 v13, v9 offset:4624
    s_mov_b64 exec, -1
    s_waitcnt lgkmcnt(0)
    s_barrier
    ds_read_b32 v220, v232 offset:0
    ds_read_b32 v221, v232 offset:1024
    ds_read_b32 v222, v232 offset:2048
    ds_read_b32 v223, v232 offset:3072
    s_waitcnt lgkmcnt(2)
    v_add_f32 v220, v220, v221
    s_waitcnt lgkmcnt(0)
    v_add_f32 v222, v222, v223
    v_add_f32 v220, v220, v222
    v_cvt_pk_bf16_f32 v12, v220, v220
    s_nop 1
    v_and_b32_dpp v36, v12, v24 row_newbcast:0 row_mask:0xf bank_mask:0xf
    v_and_b32_dpp v37, v12, v25 row_newbcast:0 row_mask:0xf bank_mask:0xf
    v_and_b32_dpp v38, v12, v26 row_newbcast:0 row_mask:0xf bank_mask:0xf
    v_and_b32_dpp v39, v12, v27 row_newbcast:0 row_mask:0xf bank_mask:0xf
    s_nop 1
    v_mfma_f32_16x16x32_bf16 v[124:127], a[0:3], v[36:39], 0
    v_and_b32_dpp v40, v12, v24 row_newbcast:1 row_mask:0xf bank_mask:0xf
    v_and_b32_dpp v41, v12, v25 row_newbcast:1 row_mask:0xf bank_mask:0xf
    v_and_b32_dpp v42, v12, v26 row_newbcast:1 row_mask:0xf bank_mask:0xf
    v_and_b32_dpp v43, v12, v27 row_newbcast:1 row_mask:0xf bank_mask:0xf
    v_mfma_f32_16x16x32_bf16 v[128:131], a[4:7], v[36:39], 0
    v_mfma_f32_16x16x32_bf16 v[132:135], a[8:11], v[36:39], 0
    v_mfma_f32_16x16x32_bf16 v[136:139], a[12:15], v[36:39], 0
    v_mfma_f32_16x16x32_bf16 v[124:127], a[16:19], v[40:43], v[124:127]
    v_and_b32_dpp v36, v12, v24 row_newbcast:2 row_mask:0xf bank_mask:0xf
    v_and_b32_dpp v37, v12, v25 row_newbcast:2 row_mask:0xf bank_mask:0xf
    v_and_b32_dpp v38, v12, v26 row_newbcast:2 row_mask:0xf bank_mask:0xf
    v_and_b32_dpp v39, v12, v27 row_newbcast:2 row_mask:0xf bank_mask:0xf
    v_mfma_f32_16x16x32_bf16 v[128:131], a[20:23], v[40:43], v[128:131]
    v_mfma_f32_16x16x32_bf16 v[132:135], a[24:27], v[40:43], v[132:135]
    v_mfma_f32_16x16x32_bf16 v[136:139], a[28:31], v[40:43], v[136:139]
    v_mfma_f32_16x16x32_bf16 v[124:127], a[32:35], v[36:39], v[124:127]
    v_and_b32_dpp v40, v12, v24 row_newbcast:3 row_mask:0xf bank_mask:0xf
    v_and_b32_dpp v41, v12, v25 row_newbcast:3 row_mask:0xf bank_mask:0xf
    v_and_b32_dpp v42, v12, v26 row_newbcast:3 row_mask:0xf bank_mask:0xf
    v_and_b32_dpp v43, v12, v27 row_newbcast:3 row_mask:0xf bank_mask:0xf
    v_mfma_f32_16x16x32_bf16 v[128:131], a[36:39], v[36:39], v[128:131]
    v_mfma_f32_16x16x32_bf16 v[132:135], a[40:43], v[36:39], v[132:135]
    v_mfma_f32_16x16x32_bf16 v[136:139], a[44:47], v[36:39], v[136:139]
    v_mfma_f32_16x16x32_bf16 v[124:127], a[48:51], v[40:43], v[124:127]
    v_and_b32_dpp v36, v12, v24 row_newbcast:4 row_mask:0xf bank_mask:0xf
    v_and_b32_dpp v37, v12, v25 row_newbcast:4 row_mask:0xf bank_mask:0xf
    v_and_b32_dpp v38, v12, v26 row_newbcast:4 row_mask:0xf bank_mask:0xf
    v_and_b32_dpp v39, v12, v27 row_newbcast:4 row_mask:0xf bank_mask:0xf
    v_mfma_f32_16x16x32_bf16 v[128:131], a[52:55], v[40:43], v[128:131]
    v_mfma_f32_16x16x32_bf16 v[132:135], a[56:59], v[40:43], v[132:135]
    v_mfma_f32_16x16x32_bf16 v[136:139], a[60:63], v[40:43], v[136:139]
    v_mfma_f32_16x16x32_bf16 v[124:127], a[64:67], v[36:39], v[124:127]
    v_and_b32_dpp v40, v12, v24 row_newbcast:5 row_mask:0xf bank_mask:0xf
    v_and_b32_dpp v41, v12, v25 row_newbcast:5 row_mask:0xf bank_mask:0xf
    v_and_b32_dpp v42, v12, v26 row_newbcast:5 row_mask:0xf bank_mask:0xf
    v_and_b32_dpp v43, v12, v27 row_newbcast:5 row_mask:0xf bank_mask:0xf
    v_mfma_f32_16x16x32_bf16 v[128:131], a[68:71], v[36:39], v[128:131]
    v_mfma_f32_16x16x32_bf16 v[132:135], a[72:75], v[36:39], v[132:135]
    v_mfma_f32_16x16x32_bf16 v[136:139], a[76:79], v[36:39], v[136:139]
    v_mfma_f32_16x16x32_bf16 v[124:127], a[80:83], v[40:43], v[124:127]
    v_and_b32_dpp v36, v12, v24 row_newbcast:6 row_mask:0xf bank_mask:0xf
    v_and_b32_dpp v37, v12, v25 row_newbcast:6 row_mask:0xf bank_mask:0xf
    v_and_b32_dpp v38, v12, v26 row_newbcast:6 row_mask:0xf bank_mask:0xf
    v_and_b32_dpp v39, v12, v27 row_newbcast:6 row_mask:0xf bank_mask:0xf
    v_mfma_f32_16x16x32_bf16 v[128:131], a[84:87], v[40:43], v[128:131]
    v_mfma_f32_16x16x32_bf16 v[132:135], a[88:91], v[40:43], v[132:135]
    v_mfma_f32_16x16x32_bf16 v[136:139], a[92:95], v[40:43], v[136:139]
    v_mfma_f32_16x16x32_bf16 v[124:127], a[96:99], v[36:39], v[124:127]
    v_and_b32_dpp v40, v12, v24 row_newbcast:7 row_mask:0xf bank_mask:0xf
    v_and_b32_dpp v41, v12, v25 row_newbcast:7 row_mask:0xf bank_mask:0xf
    v_and_b32_dpp v42, v12, v26 row_newbcast:7 row_mask:0xf bank_mask:0xf
    v_and_b32_dpp v43, v12, v27 row_newbcast:7 row_mask:0xf bank_mask:0xf
    v_mfma_f32_16x16x32_bf16 v[128:131], a[100:103], v[36:39], v[128:131]
    v_mfma_f32_16x16x32_bf16 v[132:135], a[104:107], v[36:39], v[132:135]
    v_mfma_f32_16x16x32_bf16 v[136:139], a[108:111], v[36:39], v[136:139]
    v_mfma_f32_16x16x32_bf16 v[124:127], a[112:115], v[40:43], v[124:127]
    v_and_b32_dpp v36, v12, v24 row_newbcast:8 row_mask:0xf bank_mask:0xf
    v_and_b32_dpp v37, v12, v25 row_newbcast:8 row_mask:0xf bank_mask:0xf
    v_and_b32_dpp v38, v12, v26 row_newbcast:8 row_mask:0xf bank_mask:0xf
    v_and_b32_dpp v39, v12, v27 row_newbcast:8 row_mask:0xf bank_mask:0xf
    v_mfma_f32_16x16x32_bf16 v[128:131], a[116:119], v[40:43], v[128:131]
    v_mfma_f32_16x16x32_bf16 v[132:135], a[120:123], v[40:43], v[132:135]
    v_mfma_f32_16x16x32_bf16 v[136:139], a[124:127], v[40:43], v[136:139]
    v_mfma_f32_16x16x32_bf16 v[124:127], a[128:131], v[36:39], v[124:127]
    v_and_b32_dpp v40, v12, v24 row_newbcast:9 row_mask:0xf bank_mask:0xf
    v_and_b32_dpp v41, v12, v25 row_newbcast:9 row_mask:0xf bank_mask:0xf
    v_and_b32_dpp v42, v12, v26 row_newbcast:9 row_mask:0xf bank_mask:0xf
    v_and_b32_dpp v43, v12, v27 row_newbcast:9 row_mask:0xf bank_mask:0xf
    v_mfma_f32_16x16x32_bf16 v[128:131], a[132:135], v[36:39], v[128:131]
    v_mfma_f32_16x16x32_bf16 v[132:135], a[136:139], v[36:39], v[132:135]
    v_mfma_f32_16x16x32_bf16 v[136:139], a[140:143], v[36:39], v[136:139]
    v_mfma_f32_16x16x32_bf16 v[124:127], a[144:147], v[40:43], v[124:127]
    v_and_b32_dpp v36, v12, v24 row_newbcast:10 row_mask:0xf bank_mask:0xf
    v_and_b32_dpp v37, v12, v25 row_newbcast:10 row_mask:0xf bank_mask:0xf
    v_and_b32_dpp v38, v12, v26 row_newbcast:10 row_mask:0xf bank_mask:0xf
    v_and_b32_dpp v39, v12, v27 row_newbcast:10 row_mask:0xf bank_mask:0xf
    v_mfma_f32_16x16x32_bf16 v[128:131], a[148:151], v[40:43], v[128:131]
    v_mfma_f32_16x16x32_bf16 v[132:135], a[152:155], v[40:43], v[132:135]
    v_mfma_f32_16x16x32_bf16 v[136:139], a[156:159], v[40:43], v[136:139]
    v_mfma_f32_16x16x32_bf16 v[124:127], a[160:163], v[36:39], v[124:127]
    v_and_b32_dpp v40, v12, v24 row_newbcast:11 row_mask:0xf bank_mask:0xf
    v_and_b32_dpp v41, v12, v25 row_newbcast:11 row_mask:0xf bank_mask:0xf
    v_and_b32_dpp v42, v12, v26 row_newbcast:11 row_mask:0xf bank_mask:0xf
    v_and_b32_dpp v43, v12, v27 row_newbcast:11 row_mask:0xf bank_mask:0xf
    v_mfma_f32_16x16x32_bf16 v[128:131], a[164:167], v[36:39], v[128:131]
    v_mfma_f32_16x16x32_bf16 v[132:135], a[168:171], v[36:39], v[132:135]
    v_mfma_f32_16x16x32_bf16 v[136:139], a[172:175], v[36:39], v[136:139]
    v_mfma_f32_16x16x32_bf16 v[124:127], a[176:179], v[40:43], v[124:127]
    v_and_b32_dpp v36, v12, v24 row_newbcast:12 row_mask:0xf bank_mask:0xf
    v_and_b32_dpp v37, v12, v25 row_newbcast:12 row_mask:0xf bank_mask:0xf
    v_and_b32_dpp v38, v12, v26 row_newbcast:12 row_mask:0xf bank_mask:0xf
    v_and_b32_dpp v39, v12, v27 row_newbcast:12 row_mask:0xf bank_mask:0xf
    v_mfma_f32_16x16x32_bf16 v[128:131], a[180:183], v[40:43], v[128:131]
    v_mfma_f32_16x16x32_bf16 v[132:135], a[184:187], v[40:43], v[132:135]
    v_mfma_f32_16x16x32_bf16 v[136:139], a[188:191], v[40:43], v[136:139]
    v_mfma_f32_16x16x32_bf16 v[124:127], a[192:195], v[36:39], v[124:127]
    v_and_b32_dpp v40, v12, v24 row_newbcast:13 row_mask:0xf bank_mask:0xf
    v_and_b32_dpp v41, v12, v25 row_newbcast:13 row_mask:0xf bank_mask:0xf
    v_and_b32_dpp v42, v12, v26 row_newbcast:13 row_mask:0xf bank_mask:0xf
    v_and_b32_dpp v43, v12, v27 row_newbcast:13 row_mask:0xf bank_mask:0xf
    v_mfma_f32_16x16x32_bf16 v[128:131], a[196:199], v[36:39], v[128:131]
    v_mfma_f32_16x16x32_bf16 v[132:135], a[200:203], v[36:39], v[132:135]
    v_mfma_f32_16x16x32_bf16 v[136:139], a[204:207], v[36:39], v[136:139]
    v_mfma_f32_16x16x32_bf16 v[124:127], a[208:211], v[40:43], v[124:127]
    v_and_b32_dpp v36, v12, v24 row_newbcast:14 row_mask:0xf bank_mask:0xf
    v_and_b32_dpp v37, v12, v25 row_newbcast:14 row_mask:0xf bank_mask:0xf
    v_and_b32_dpp v38, v12, v26 row_newbcast:14 row_mask:0xf bank_mask:0xf
    v_and_b32_dpp v39, v12, v27 row_newbcast:14 row_mask:0xf bank_mask:0xf
    v_mfma_f32_16x16x32_bf16 v[128:131], a[212:215], v[40:43], v[128:131]
    v_mfma_f32_16x16x32_bf16 v[132:135], a[216:219], v[40:43], v[132:135]
    v_mfma_f32_16x16x32_bf16 v[136:139], a[220:223], v[40:43], v[136:139]
    v_mfma_f32_16x16x32_bf16 v[124:127], a[224:227], v[36:39], v[124:127]
    v_and_b32_dpp v40, v12, v24 row_newbcast:15 row_mask:0xf bank_mask:0xf
    v_and_b32_dpp v41, v12, v25 row_newbcast:15 row_mask:0xf bank_mask:0xf
    v_and_b32_dpp v42, v12, v26 row_newbcast:15 row_mask:0xf bank_mask:0xf
    v_and_b32_dpp v43, v12, v27 row_newbcast:15 row_mask:0xf bank_mask:0xf
    v_mfma_f32_16x16x32_bf16 v[128:131], a[228:231], v[36:39], v[128:131]
    v_mfma_f32_16x16x32_bf16 v[132:135], a[232:235], v[36:39], v[132:135]
    v_mfma_f32_16x16x32_bf16 v[136:139], a[236:239], v[36:39], v[136:139]
    v_mfma_f32_16x16x32_bf16 v[124:127], a[240:243], v[40:43], v[124:127]
    v_mfma_f32_16x16x32_bf16 v[128:131], a[244:247], v[40:43], v[128:131]
    v_mfma_f32_16x16x32_bf16 v[132:135], a[248:251], v[40:43], v[132:135]
    v_mfma_f32_16x16x32_bf16 v[136:139], a[252:255], v[40:43], v[136:139]
    s_mov_b32 exec_lo, 0x00ff00ff
    s_mov_b32 exec_hi, 0x00ff00ff
    s_nop 3
    ds_write_b32 v231, v124 offset:5120
    ds_write_b32 v231, v125 offset:5152
    ds_write_b32 v231, v128 offset:5568
    ds_write_b32 v231, v129 offset:5600
    ds_write_b32 v231, v132 offset:6016
    ds_write_b32 v231, v133 offset:6048
    s_nop 3
    ds_write_b32 v231, v136 offset:6464
    ds_write_b32 v231, v137 offset:6496
    s_mov_b32 exec_hi, 0x000000ff
    ds_write_b32 v231, v126 offset:5184
    ds_write_b32 v231, v127 offset:5216
    ds_write_b32 v231, v130 offset:5632
    ds_write_b32 v231, v131 offset:5664
    ds_write_b32 v231, v134 offset:6080
    ds_write_b32 v231, v135 offset:6112
    ds_write_b32 v231, v138 offset:6528
    ds_write_b32 v231, v139 offset:6560
    s_mov_b64 exec, -1
    s_waitcnt lgkmcnt(0)
    s_barrier
    ds_read_b64 v[92:93], v233 offset:5120
    ds_read_b64 v[94:95], v233 offset:7168
    ds_read_b64 v[96:97], v233 offset:9216
    ds_read_b64 v[98:99], v233 offset:11264
    v_mov_b32 v14, 0
    ds_read_b128 v[220:223], v14 offset:4624
    s_mul_i32 s53, s51, 2048
    v_mov_b32 v15, 0xffffff00
    v_cmp_gt_u32 vcc, 224, v0
    s_waitcnt lgkmcnt(1)
    v_add_f32 v92, v92, v94
    v_add_f32 v96, v96, v98
    v_add_f32 v93, v93, v95
    v_add_f32 v97, v97, v99
    v_add_f32 v92, v92, v96
    v_add_f32 v93, v93, v97
    v_bfi_b32 v92, v15, v92, s74
    v_bfi_b32 v93, v15, v93, s74
    s_and_saveexec_b64 s[64:65], vcc
    s_cbranch_execz L_row_done
    buffer_store_dwordx2 v[92:93], v233, s[40:43], s53 offen sc1
L_row_done:
    s_mov_b64 exec, s[64:65]
    s_cmp_lg_u32 s3, 3
    s_cbranch_scc1 L_ml_done
    s_waitcnt lgkmcnt(0)
    v_add_f32 v220, v220, v221
    v_add_f32 v222, v222, v223
    v_add_f32 v222, v220, v222
    v_bfi_b32 v220, v15, v8, s74
    v_lshl_or_b32 v221, v8, 8, s74
    v_bfi_b32 v222, v15, v222, s74
    v_mov_b32 v223, s74
    s_lshl_b32 s53, s51, 4
    s_add_u32 s53, s53, 524288
    v_mov_b32 v14, 0
    s_mov_b64 exec, 1
    buffer_store_dwordx4 v[220:223], v14, s[40:43], s53 offen sc1
    s_mov_b64 exec, -1
L_ml_done:
    s_cmp_lg_u32 s3, 0
    s_cbranch_scc1 L_tk_done
    s_waitcnt vmcnt(1)
    v_mov_b32 v14, 0
    s_mov_b64 exec, 1
    ds_write_b32 v14, v228 offset:4640
    s_mov_b64 exec, -1
L_tk_done:
    s_waitcnt lgkmcnt(0)
    s_barrier
    v_mov_b32 v14, 0
    ds_read_b32 v13, v14 offset:4640
    s_waitcnt lgkmcnt(0)
    v_readfirstlane_b32 s70, v13
    s_nop 3
    s_and_b32 s70, s70, 63
    s_cmp_lt_u32 s70, 57
    s_cbranch_scc1 L_fin_skip
    s_cmp_lg_u32 s70, 63
    s_cbranch_scc1 L_ep_done
    s_cmp_lg_u32 s3, 0
    s_cbranch_scc1 L_ep_done
    s_lshl_b32 s53, s49, 12
    s_add_u32 s53, s53, 1179648
    v_mov_b32 v14, 0
    v_mov_b32 v13, s73
    s_mov_b64 exec, 1
    buffer_store_dword v13, v14, s[40:43], s53 offen sc1
    s_mov_b64 exec, -1
L_ep_done:
    s_sub_u32 s70, s70, 57
    s_lshl_b32 s53, s49, 6
    s_lshl_b32 s54, s3, 4
    s_add_u32 s54, s54, s53
    v_lshrrev_b32 v13, 4, v1
    v_lshlrev_b32 v13, 2, v13
    v_add_u32 v13, s54, v13
    v_and_b32 v14, 3, v1
    v_add_u32 v14, v14, v13
    v_lshlrev_b32 v14, 4, v14
    v_add_u32 v14, 524288, v14
    v_mul_u32_u24 v13, 2048, v13
    v_and_b32 v11, 15, v1
    v_lshl_add_u32 v13, v11, 4, v13
    s_lshl_b32 s53, s70, 8
    v_add_u32 v13, s53, v13
    s_mov_b32 s71, 262144
    s_mov_b32 s72, 4096
    s_mov_b32 s69, 0x07060501
L_fpoll:
    buffer_load_dwordx4 v[220:223], v14, s[40:43], 0 offen sc1
    buffer_load_dwordx4 v[92:95], v13, s[40:43], 0 offen offset:0 sc1
    buffer_load_dwordx4 v[96:99], v13, s[40:43], 0 offen offset:2048 sc1
    buffer_load_dwordx4 v[100:103], v13, s[40:43], s72 offen offset:0 sc1
    buffer_load_dwordx4 v[104:107], v13, s[40:43], s72 offen offset:2048 sc1
    s_waitcnt vmcnt(4)
    v_xor_b32 v11, s74, v220
    v_xor_b32 v12, s74, v221
    v_xor_b32 v10, s74, v222
    v_or3_b32 v11, v11, v12, v10
    s_waitcnt vmcnt(3)
    v_xor_b32 v12, s74, v92
    v_xor_b32 v10, s74, v93
    v_or3_b32 v11, v11, v12, v10
    v_xor_b32 v12, s74, v94
    v_xor_b32 v10, s74, v95
    v_or3_b32 v11, v11, v12, v10
    s_waitcnt vmcnt(2)
    v_xor_b32 v12, s74, v96
    v_xor_b32 v10, s74, v97
    v_or3_b32 v11, v11, v12, v10
    v_xor_b32 v12, s74, v98
    v_xor_b32 v10, s74, v99
    v_or3_b32 v11, v11, v12, v10
    s_waitcnt vmcnt(1)
    v_xor_b32 v12, s74, v100
    v_xor_b32 v10, s74, v101
    v_or3_b32 v11, v11, v12, v10
    v_xor_b32 v12, s74, v102
    v_xor_b32 v10, s74, v103
    v_or3_b32 v11, v11, v12, v10
    s_waitcnt vmcnt(0)
    v_xor_b32 v12, s74, v104
    v_xor_b32 v10, s74, v105
    v_or3_b32 v11, v11, v12, v10
    v_xor_b32 v12, s74, v106
    v_xor_b32 v10, s74, v107
    v_or3_b32 v11, v11, v12, v10
    v_and_b32 v11, 0xff, v11
    v_cmp_ne_u32 vcc, 0, v11
    s_sub_u32 s71, s71, 1
    s_nop 3
    s_cbranch_vccz L_fgo
    s_cmp_lg_u32 s71, 0
    s_cbranch_scc1 L_fpoll
L_fgo:
    v_perm_b32 v220, v220, v221, s69
    s_nop 1
    v_max_f32_dpp v224, v220, v220 quad_perm:[1,0,3,2] row_mask:0xf bank_mask:0xf
    s_nop 1
    v_max_f32_dpp v224, v224, v224 quad_perm:[2,3,0,1] row_mask:0xf bank_mask:0xf
    v_sub_f32 v225, v220, v224
    v_mul_f32 v225, s55, v225
    v_exp_f32 v225, v225
    s_nop 0
    v_mul_f32 v222, v222, v225
    s_nop 1
    v_add_f32_dpp v222, v222, v222 quad_perm:[1,0,3,2] row_mask:0xf bank_mask:0xf
    s_nop 1
    v_add_f32_dpp v222, v222, v222 quad_perm:[2,3,0,1] row_mask:0xf bank_mask:0xf
    v_rcp_f32 v222, v222
    s_nop 0
    v_mul_f32 v225, v225, v222
    s_nop 1
    v_mov_b32_dpp v20, v225 quad_perm:[0,0,0,0] row_mask:0xf bank_mask:0xf
    v_mov_b32_dpp v21, v225 quad_perm:[1,1,1,1] row_mask:0xf bank_mask:0xf
    v_mov_b32_dpp v22, v225 quad_perm:[2,2,2,2] row_mask:0xf bank_mask:0xf
    v_mov_b32_dpp v23, v225 quad_perm:[3,3,3,3] row_mask:0xf bank_mask:0xf
    s_nop 0
    v_mul_f32 v16, v20, v92
    v_mul_f32 v17, v20, v93
    v_mul_f32 v18, v20, v94
    v_mul_f32 v19, v20, v95
    v_fmac_f32 v16, v21, v96
    v_fmac_f32 v17, v21, v97
    v_fmac_f32 v18, v21, v98
    v_fmac_f32 v19, v21, v99
    v_fmac_f32 v16, v22, v100
    v_fmac_f32 v17, v22, v101
    v_fmac_f32 v18, v22, v102
    v_fmac_f32 v19, v22, v103
    v_fmac_f32 v16, v23, v104
    v_fmac_f32 v17, v23, v105
    v_fmac_f32 v18, v23, v106
    v_fmac_f32 v19, v23, v107
    s_lshl_b32 s53, s3, 10
    v_lshlrev_b32 v13, 4, v1
    v_add_u32 v13, s53, v13
    ds_write_b128 v13, v[16:19] offset:0
    s_waitcnt lgkmcnt(0)
    s_barrier
    s_cmp_lg_u32 s3, 0
    s_cbranch_scc1 L_fin_skip
    v_lshlrev_b32 v13, 3, v1
    s_mov_b32 exec_hi, 0
    ds_read_b64 v[92:93], v13 offset:0
    ds_read_b64 v[94:95], v13 offset:256
    ds_read_b64 v[96:97], v13 offset:512
    ds_read_b64 v[98:99], v13 offset:768
    ds_read_b64 v[100:101], v13 offset:1024
    ds_read_b64 v[102:103], v13 offset:1280
    ds_read_b64 v[104:105], v13 offset:1536
    ds_read_b64 v[106:107], v13 offset:1792
    ds_read_b64 v[108:109], v13 offset:2048
    ds_read_b64 v[110:111], v13 offset:2304
    ds_read_b64 v[112:113], v13 offset:2560
    ds_read_b64 v[114:115], v13 offset:2816
    ds_read_b64 v[116:117], v13 offset:3072
    ds_read_b64 v[118:119], v13 offset:3328
    ds_read_b64 v[120:121], v13 offset:3584
    ds_read_b64 v[122:123], v13 offset:3840
    s_mul_i32 s53, s49, 896
    s_lshl_b32 s72, s70, 7
    s_add_u32 s53, s53, s72
    v_lshlrev_b32 v14, 2, v1
    s_waitcnt lgkmcnt(0)
    v_add_f32 v92, v92, v94
    v_add_f32 v93, v93, v95
    v_add_f32 v96, v96, v98
    v_add_f32 v97, v97, v99
    v_add_f32 v100, v100, v102
    v_add_f32 v101, v101, v103
    v_add_f32 v104, v104, v106
    v_add_f32 v105, v105, v107
    v_add_f32 v108, v108, v110
    v_add_f32 v109, v109, v111
    v_add_f32 v112, v112, v114
    v_add_f32 v113, v113, v115
    v_add_f32 v116, v116, v118
    v_add_f32 v117, v117, v119
    v_add_f32 v120, v120, v122
    v_add_f32 v121, v121, v123
    v_add_f32 v92, v92, v96
    v_add_f32 v93, v93, v97
    v_add_f32 v100, v100, v104
    v_add_f32 v101, v101, v105
    v_add_f32 v108, v108, v112
    v_add_f32 v109, v109, v113
    v_add_f32 v116, v116, v120
    v_add_f32 v117, v117, v121
    v_add_f32 v92, v92, v100
    v_add_f32 v93, v93, v101
    v_add_f32 v108, v108, v116
    v_add_f32 v109, v109, v117
    v_add_f32 v92, v92, v108
    v_add_f32 v93, v93, v109
    v_cvt_pk_bf16_f32 v92, v92, v93
    buffer_store_dword v92, v14, s[44:47], s53 offen
    s_mov_b64 exec, -1
L_fin_skip:
L_end:
    s_endpgm
L_qslow:
    s_mov_b32 s71, 4096
L_qpoll:
    buffer_load_dwordx4 v[60:63], v14, s[40:43], 0 offen offset:0 sc1
    buffer_load_dwordx4 v[64:67], v14, s[40:43], 0 offen offset:16 sc1
    buffer_load_dwordx4 v[68:71], v14, s[40:43], 0 offen offset:512 sc1
    buffer_load_dwordx4 v[72:75], v14, s[40:43], 0 offen offset:528 sc1
    s_waitcnt vmcnt(0)
    v_xor_b32 v11, s68, v60
    v_xor_b32 v12, s68, v61
    v_xor_b32 v10, s68, v62
    v_or3_b32 v11, v11, v12, v10
    v_xor_b32 v12, s68, v63
    v_xor_b32 v10, s68, v64
    v_or3_b32 v11, v11, v12, v10
    v_xor_b32 v12, s68, v65
    v_xor_b32 v10, s68, v66
    v_or3_b32 v11, v11, v12, v10
    v_xor_b32 v12, s68, v67
    v_xor_b32 v10, s68, v68
    v_or3_b32 v11, v11, v12, v10
    v_xor_b32 v12, s68, v69
    v_xor_b32 v10, s68, v70
    v_or3_b32 v11, v11, v12, v10
    v_xor_b32 v12, s68, v71
    v_xor_b32 v10, s68, v72
    v_or3_b32 v11, v11, v12, v10
    v_xor_b32 v12, s68, v73
    v_xor_b32 v10, s68, v74
    v_or3_b32 v11, v11, v12, v10
    v_xor_b32 v12, s68, v75
    v_or_b32 v11, v11, v12
    v_and_b32 v11, 0xffff, v11
    v_cmp_ne_u32 vcc, 0, v11
    s_nop 4
    s_cbranch_vccz L_qpack
    s_sub_u32 s71, s71, 1
    s_cmp_lg_u32 s71, 0
    s_cbranch_scc1 L_qpoll
    s_lshl_b32 s70, s3, 13
    v_lshrrev_b32 v13, 4, v1
    v_lshlrev_b32 v13, 7, v13
    v_and_b32 v15, 7, v1
    v_lshl_add_u32 v13, v15, 2, v13
    v_add_u32 v13, s70, v13
    s_mov_b32 s71, 0
L_qfb:
    s_and_b32 s72, s71, 3
    s_mul_i32 s67, s72, 224
    s_mul_i32 s66, s72, 917504
    s_lshr_b32 s72, s71, 2
    s_lshl_b32 s72, s72, 7
    s_add_u32 s66, s66, s72
    v_mov_b32 v16, 0
    v_mov_b32 v17, 0
    v_mov_b32 v18, 0
    v_mov_b32 v19, 0
    v_mov_b32 v20, 0
    v_mov_b32 v21, 0
    v_mov_b32 v22, 0
    v_mov_b32 v23, 0
    buffer_load_dwordx4 v[44:47], v6, s[36:39], s67 offen
    buffer_load_dwordx3 v[48:50], v6, s[36:39], s67 offen offset:16
    buffer_load_dwordx4 a[0:3], v4, s[28:31], s66 offen nt
    s_add_u32 s53, s66, 8192
    buffer_load_dwordx4 a[4:7], v4, s[28:31], s53 offen nt
    s_add_u32 s53, s66, 16384
    buffer_load_dwordx4 a[8:11], v4, s[28:31], s53 offen nt
    s_add_u32 s53, s66, 24576
    buffer_load_dwordx4 a[12:15], v4, s[28:31], s53 offen nt
    s_add_u32 s53, s66, 32768
    buffer_load_dwordx4 a[16:19], v4, s[28:31], s53 offen nt
    s_add_u32 s53, s66, 40960
    buffer_load_dwordx4 a[20:23], v4, s[28:31], s53 offen nt
    s_add_u32 s53, s66, 49152
    buffer_load_dwordx4 a[24:27], v4, s[28:31], s53 offen nt
    s_add_u32 s53, s66, 57344
    buffer_load_dwordx4 a[28:31], v4, s[28:31], s53 offen nt
    s_add_u32 s53, s66, 65536
    buffer_load_dwordx4 a[32:35], v4, s[28:31], s53 offen nt
    s_add_u32 s53, s66, 73728
    buffer_load_dwordx4 a[36:39], v4, s[28:31], s53 offen nt
    s_add_u32 s53, s66, 81920
    buffer_load_dwordx4 a[40:43], v4, s[28:31], s53 offen nt
    s_add_u32 s53, s66, 90112
    buffer_load_dwordx4 a[44:47], v4, s[28:31], s53 offen nt
    s_add_u32 s53, s66, 98304
    buffer_load_dwordx4 a[48:51], v4, s[28:31], s53 offen nt
    s_add_u32 s53, s66, 106496
    buffer_load_dwordx4 a[52:55], v4, s[28:31], s53 offen nt
    s_waitcnt vmcnt(15)
    v_perm_b32 v36, v44, v44, v28
    v_perm_b32 v37, v44, v44, v30
    v_perm_b32 v38, v44, v44, v32
    v_perm_b32 v39, v44, v44, v34
    s_waitcnt vmcnt(13)
    s_nop 1
    v_mfma_f32_16x16x32_bf16 v[16:19], a[0:3], v[36:39], v[16:19]
    v_perm_b32 v40, v44, v44, v29
    v_perm_b32 v41, v44, v44, v31
    v_perm_b32 v42, v44, v44, v33
    v_perm_b32 v43, v44, v44, v35
    s_waitcnt vmcnt(12)
    s_nop 1
    v_mfma_f32_16x16x32_bf16 v[20:23], a[4:7], v[40:43], v[20:23]
    v_perm_b32 v36, v45, v45, v28
    v_perm_b32 v37, v45, v45, v30
    v_perm_b32 v38, v45, v45, v32
    v_perm_b32 v39, v45, v45, v34
    s_waitcnt vmcnt(11)
    s_nop 1
    v_mfma_f32_16x16x32_bf16 v[16:19], a[8:11], v[36:39], v[16:19]
    v_perm_b32 v40, v45, v45, v29
    v_perm_b32 v41, v45, v45, v31
    v_perm_b32 v42, v45, v45, v33
    v_perm_b32 v43, v45, v45, v35
    s_waitcnt vmcnt(10)
    s_nop 1
    v_mfma_f32_16x16x32_bf16 v[20:23], a[12:15], v[40:43], v[20:23]
    v_perm_b32 v36, v46, v46, v28
    v_perm_b32 v37, v46, v46, v30
    v_perm_b32 v38, v46, v46, v32
    v_perm_b32 v39, v46, v46, v34
    s_waitcnt vmcnt(9)
    s_nop 1
    v_mfma_f32_16x16x32_bf16 v[16:19], a[16:19], v[36:39], v[16:19]
    v_perm_b32 v40, v46, v46, v29
    v_perm_b32 v41, v46, v46, v31
    v_perm_b32 v42, v46, v46, v33
    v_perm_b32 v43, v46, v46, v35
    s_waitcnt vmcnt(8)
    s_nop 1
    v_mfma_f32_16x16x32_bf16 v[20:23], a[20:23], v[40:43], v[20:23]
    v_perm_b32 v36, v47, v47, v28
    v_perm_b32 v37, v47, v47, v30
    v_perm_b32 v38, v47, v47, v32
    v_perm_b32 v39, v47, v47, v34
    s_waitcnt vmcnt(7)
    s_nop 1
    v_mfma_f32_16x16x32_bf16 v[16:19], a[24:27], v[36:39], v[16:19]
    v_perm_b32 v40, v47, v47, v29
    v_perm_b32 v41, v47, v47, v31
    v_perm_b32 v42, v47, v47, v33
    v_perm_b32 v43, v47, v47, v35
    s_waitcnt vmcnt(6)
    s_nop 1
    v_mfma_f32_16x16x32_bf16 v[20:23], a[28:31], v[40:43], v[20:23]
    v_perm_b32 v36, v48, v48, v28
    v_perm_b32 v37, v48, v48, v30
    v_perm_b32 v38, v48, v48, v32
    v_perm_b32 v39, v48, v48, v34
    s_waitcnt vmcnt(5)
    s_nop 1
    v_mfma_f32_16x16x32_bf16 v[16:19], a[32:35], v[36:39], v[16:19]
    v_perm_b32 v40, v48, v48, v29
    v_perm_b32 v41, v48, v48, v31
    v_perm_b32 v42, v48, v48, v33
    v_perm_b32 v43, v48, v48, v35
    s_waitcnt vmcnt(4)
    s_nop 1
    v_mfma_f32_16x16x32_bf16 v[20:23], a[36:39], v[40:43], v[20:23]
    v_perm_b32 v36, v49, v49, v28
    v_perm_b32 v37, v49, v49, v30
    v_perm_b32 v38, v49, v49, v32
    v_perm_b32 v39, v49, v49, v34
    s_waitcnt vmcnt(3)
    s_nop 1
    v_mfma_f32_16x16x32_bf16 v[16:19], a[40:43], v[36:39], v[16:19]
    v_perm_b32 v40, v49, v49, v29
    v_perm_b32 v41, v49, v49, v31
    v_perm_b32 v42, v49, v49, v33
    v_perm_b32 v43, v49, v49, v35
    s_waitcnt vmcnt(2)
    s_nop 1
    v_mfma_f32_16x16x32_bf16 v[20:23], a[44:47], v[40:43], v[20:23]
    v_perm_b32 v36, v50, v50, v28
    v_perm_b32 v37, v50, v50, v30
    v_perm_b32 v38, v50, v50, v32
    v_perm_b32 v39, v50, v50, v34
    s_waitcnt vmcnt(1)
    s_nop 1
    v_mfma_f32_16x16x32_bf16 v[16:19], a[48:51], v[36:39], v[16:19]
    v_perm_b32 v40, v50, v50, v29
    v_perm_b32 v41, v50, v50, v31
    v_perm_b32 v42, v50, v50, v33
    v_perm_b32 v43, v50, v50, v35
    s_waitcnt vmcnt(0)
    s_nop 1
    v_mfma_f32_16x16x32_bf16 v[20:23], a[52:55], v[40:43], v[20:23]
    s_nop 7
    v_add_f32 v16, v16, v20
    v_add_f32 v17, v17, v21
    v_add_f32 v18, v18, v22
    v_add_f32 v19, v19, v23
    s_and_b32 s53, s71, 3
    s_lshl_b32 s53, s53, 9
    v_add_u32 v220, s53, v13
    s_mov_b32 exec_lo, 0x00ff00ff
    s_mov_b32 exec_hi, 0xff00ff00
    ds_write_b32 v220, v16 offset:16384
    ds_write_b32 v220, v17 offset:16416
    ds_write_b32 v220, v18 offset:16448
    ds_write_b32 v220, v19 offset:16480
    s_mov_b64 exec, -1
    s_and_b32 s53, s71, 3
    s_cmp_lg_u32 s53, 3
    s_cbranch_scc1 L_qfbn
    v_lshlrev_b32 v220, 3, v1
    v_add_u32 v220, s70, v220
    s_mov_b32 exec_hi, 0
    s_waitcnt lgkmcnt(0)
    ds_read_b64 v[60:61], v220 offset:16384
    ds_read_b64 v[62:63], v220 offset:16640
    ds_read_b64 v[64:65], v220 offset:16896
    ds_read_b64 v[66:67], v220 offset:17152
    ds_read_b64 v[68:69], v220 offset:17408
    ds_read_b64 v[70:71], v220 offset:17664
    ds_read_b64 v[72:73], v220 offset:17920
    ds_read_b64 v[74:75], v220 offset:18176
    s_lshr_b32 s53, s71, 2
    s_lshl_b32 s53, s53, 7
    s_add_u32 s53, s53, s70
    v_lshlrev_b32 v220, 2, v1
    v_add_u32 v220, s53, v220
    s_waitcnt lgkmcnt(0)
    v_add_f32 v60, v60, v62
    v_add_f32 v61, v61, v63
    v_add_f32 v64, v64, v66
    v_add_f32 v65, v65, v67
    v_add_f32 v68, v68, v70
    v_add_f32 v69, v69, v71
    v_add_f32 v72, v72, v74
    v_add_f32 v73, v73, v75
    v_add_f32 v60, v60, v64
    v_add_f32 v61, v61, v65
    v_add_f32 v68, v68, v72
    v_add_f32 v69, v69, v73
    v_add_f32 v60, v60, v68
    v_add_f32 v61, v61, v69
    v_cvt_pk_bf16_f32 v60, v60, v61
    ds_write_b32 v220, v60 offset:18432
    s_mov_b64 exec, -1
    s_waitcnt lgkmcnt(0)
L_qfbn:
    s_add_u32 s71, s71, 1
    s_cmp_lg_u32 s71, 16
    s_cbranch_scc1 L_qfb
    v_lshrrev_b32 v13, 4, v1
    v_lshlrev_b32 v13, 6, v13
    v_and_b32 v15, 3, v1
    v_lshl_add_u32 v13, v15, 4, v13
    v_add_u32 v13, s70, v13
    ds_read_b128 v[220:223], v13 offset:18432
    ds_read_b128 v[224:227], v13 offset:18688
    s_waitcnt vmcnt(0) lgkmcnt(0)
    s_branch L_qready
L_qalt:
    s_add_u32 s53, s81, 163840
    s_and_b32 s53, s53, 0xfffff
    buffer_load_dwordx4 v[100:103], v2, s[20:23], s53 offen offset:2048 nt
    s_add_u32 s53, s81, 163840
    s_and_b32 s53, s53, 0xfffff
    buffer_load_dwordx4 v[104:107], v2, s[20:23], s53 offen offset:2304 nt
    s_add_u32 s53, s81, 180224
    s_and_b32 s53, s53, 0xfffff
    buffer_load_dwordx4 v[108:111], v2, s[20:23], s53 offen offset:0 nt
    s_add_u32 s53, s81, 180224
    s_and_b32 s53, s53, 0xfffff
    buffer_load_dwordx4 v[112:115], v2, s[20:23], s53 offen offset:256 nt
    s_add_u32 s53, s81, 180224
    s_and_b32 s53, s53, 0xfffff
    buffer_load_dwordx4 v[116:119], v2, s[20:23], s53 offen offset:2048 nt
    s_add_u32 s53, s81, 180224
    s_and_b32 s53, s53, 0xfffff
    buffer_load_dwordx4 v[120:123], v2, s[20:23], s53 offen offset:2304 nt
    s_add_u32 s53, s81, 0
    s_and_b32 s53, s53, 0xfffff
    buffer_load_dwordx4 v[124:127], v2, s[20:23], s53 offen offset:0 nt
    s_add_u32 s53, s81, 0
    s_and_b32 s53, s53, 0xfffff
    buffer_load_dwordx4 v[128:131], v2, s[20:23], s53 offen offset:256 nt
    s_add_u32 s53, s81, 0
    s_and_b32 s53, s53, 0xfffff
    buffer_load_dwordx4 v[132:135], v2, s[20:23], s53 offen offset:2048 nt
    s_add_u32 s53, s81, 0
    s_and_b32 s53, s53, 0xfffff
    buffer_load_dwordx4 v[136:139], v2, s[20:23], s53 offen offset:2304 nt
    s_add_u32 s53, s81, 16384
    s_and_b32 s53, s53, 0xfffff
    buffer_load_dwordx4 v[140:143], v2, s[20:23], s53 offen offset:0 nt
    s_add_u32 s53, s81, 16384
    s_and_b32 s53, s53, 0xfffff
    buffer_load_dwordx4 v[144:147], v2, s[20:23], s53 offen offset:256 nt
    s_add_u32 s53, s81, 16384
    s_and_b32 s53, s53, 0xfffff
    buffer_load_dwordx4 v[148:151], v2, s[20:23], s53 offen offset:2048 nt
    s_add_u32 s53, s81, 16384
    s_and_b32 s53, s53, 0xfffff
    buffer_load_dwordx4 v[152:155], v2, s[20:23], s53 offen offset:2304 nt
    v_and_b32 v15, 1, v14
    v_cmp_eq_u32 vcc, 1, v15
    v_mov_b32 v11, 0x0c0c0100
    v_mov_b32 v12, 0x01000c0c
    v_cndmask_b32 v11, v11, v12, vcc
    v_mov_b32 v12, 0x0c0c0302
    v_mov_b32 v10, 0x03020c0c
    v_cndmask_b32 v12, v12, v10, vcc
    v_mov_b32 v10, 0x0000ffff
    v_mov_b32 v9, 0xffff0000
    v_cndmask_b32 v10, v10, v9, vcc
    v_lshrrev_b32 v15, 1, v14
    v_mov_b32 v9, 0x0c0c0c0c
    v_cmp_eq_u32 vcc, 0, v15
    s_nop 1
    v_cndmask_b32 v24, 0, v10, vcc
    v_cmp_eq_u32 vcc, 1, v15
    s_nop 1
    v_cndmask_b32 v25, 0, v10, vcc
    v_cmp_eq_u32 vcc, 2, v15
    s_nop 1
    v_cndmask_b32 v26, 0, v10, vcc
    v_cmp_eq_u32 vcc, 3, v15
    s_nop 1
    v_cndmask_b32 v27, 0, v10, vcc
    v_and_b32 v15, 3, v15
    v_cmp_eq_u32 vcc, 0, v15
    s_nop 1
    v_cndmask_b32 v28, v9, v11, vcc
    v_cndmask_b32 v29, v9, v12, vcc
    v_cmp_eq_u32 vcc, 1, v15
    s_nop 1
    v_cndmask_b32 v30, v9, v11, vcc
    v_cndmask_b32 v31, v9, v12, vcc
    v_cmp_eq_u32 vcc, 2, v15
    s_nop 1
    v_cndmask_b32 v32, v9, v11, vcc
    v_cndmask_b32 v33, v9, v12, vcc
    v_cmp_eq_u32 vcc, 3, v15
    s_nop 1
    v_cndmask_b32 v34, v9, v11, vcc
    v_cndmask_b32 v35, v9, v12, vcc
    v_mov_b32 v9, 0
    s_waitcnt vmcnt(29)
    v_perm_b32 v36, v44, v44, v28
    v_perm_b32 v37, v44, v44, v30
    v_perm_b32 v38, v44, v44, v32
    v_perm_b32 v39, v44, v44, v34
    s_waitcnt vmcnt(27)
    s_nop 1
    v_mfma_f32_16x16x32_bf16 v[16:19], a[0:3], v[36:39], 0
    v_perm_b32 v40, v44, v44, v29
    v_perm_b32 v41, v44, v44, v31
    v_perm_b32 v42, v44, v44, v33
    v_perm_b32 v43, v44, v44, v35
    s_waitcnt vmcnt(26)
    s_nop 1
    v_mfma_f32_16x16x32_bf16 v[20:23], a[4:7], v[40:43], 0
    v_perm_b32 v36, v45, v45, v28
    v_perm_b32 v37, v45, v45, v30
    v_perm_b32 v38, v45, v45, v32
    v_perm_b32 v39, v45, v45, v34
    s_waitcnt vmcnt(25)
    s_nop 1
    v_mfma_f32_16x16x32_bf16 v[16:19], a[8:11], v[36:39], v[16:19]
    v_perm_b32 v40, v45, v45, v29
    v_perm_b32 v41, v45, v45, v31
    v_perm_b32 v42, v45, v45, v33
    v_perm_b32 v43, v45, v45, v35
    s_waitcnt vmcnt(24)
    s_nop 1
    v_mfma_f32_16x16x32_bf16 v[20:23], a[12:15], v[40:43], v[20:23]
    v_perm_b32 v36, v46, v46, v28
    v_perm_b32 v37, v46, v46, v30
    v_perm_b32 v38, v46, v46, v32
    v_perm_b32 v39, v46, v46, v34
    s_waitcnt vmcnt(23)
    s_nop 1
    v_mfma_f32_16x16x32_bf16 v[16:19], a[16:19], v[36:39], v[16:19]
    v_perm_b32 v40, v46, v46, v29
    v_perm_b32 v41, v46, v46, v31
    v_perm_b32 v42, v46, v46, v33
    v_perm_b32 v43, v46, v46, v35
    s_waitcnt vmcnt(22)
    s_nop 1
    v_mfma_f32_16x16x32_bf16 v[20:23], a[20:23], v[40:43], v[20:23]
    v_perm_b32 v36, v47, v47, v28
    v_perm_b32 v37, v47, v47, v30
    v_perm_b32 v38, v47, v47, v32
    v_perm_b32 v39, v47, v47, v34
    s_waitcnt vmcnt(21)
    s_nop 1
    v_mfma_f32_16x16x32_bf16 v[16:19], a[24:27], v[36:39], v[16:19]
    v_perm_b32 v40, v47, v47, v29
    v_perm_b32 v41, v47, v47, v31
    v_perm_b32 v42, v47, v47, v33
    v_perm_b32 v43, v47, v47, v35
    s_waitcnt vmcnt(20)
    s_nop 1
    v_mfma_f32_16x16x32_bf16 v[20:23], a[28:31], v[40:43], v[20:23]
    v_perm_b32 v36, v48, v48, v28
    v_perm_b32 v37, v48, v48, v30
    v_perm_b32 v38, v48, v48, v32
    v_perm_b32 v39, v48, v48, v34
    s_waitcnt vmcnt(19)
    s_nop 1
    v_mfma_f32_16x16x32_bf16 v[16:19], a[32:35], v[36:39], v[16:19]
    v_perm_b32 v40, v48, v48, v29
    v_perm_b32 v41, v48, v48, v31
    v_perm_b32 v42, v48, v48, v33
    v_perm_b32 v43, v48, v48, v35
    s_waitcnt vmcnt(18)
    s_nop 1
    v_mfma_f32_16x16x32_bf16 v[20:23], a[36:39], v[40:43], v[20:23]
    v_perm_b32 v36, v49, v49, v28
    v_perm_b32 v37, v49, v49, v30
    v_perm_b32 v38, v49, v49, v32
    v_perm_b32 v39, v49, v49, v34
    s_waitcnt vmcnt(17)
    s_nop 1
    v_mfma_f32_16x16x32_bf16 v[16:19], a[40:43], v[36:39], v[16:19]
    v_perm_b32 v40, v49, v49, v29
    v_perm_b32 v41, v49, v49, v31
    v_perm_b32 v42, v49, v49, v33
    v_perm_b32 v43, v49, v49, v35
    s_waitcnt vmcnt(16)
    s_nop 1
    v_mfma_f32_16x16x32_bf16 v[20:23], a[44:47], v[40:43], v[20:23]
    v_perm_b32 v36, v50, v50, v28
    v_perm_b32 v37, v50, v50, v30
    v_perm_b32 v38, v50, v50, v32
    v_perm_b32 v39, v50, v50, v34
    s_waitcnt vmcnt(15)
    s_nop 1
    v_mfma_f32_16x16x32_bf16 v[16:19], a[48:51], v[36:39], v[16:19]
    v_perm_b32 v40, v50, v50, v29
    v_perm_b32 v41, v50, v50, v31
    v_perm_b32 v42, v50, v50, v33
    v_perm_b32 v43, v50, v50, v35
    s_waitcnt vmcnt(14)
    s_nop 1
    v_mfma_f32_16x16x32_bf16 v[20:23], a[52:55], v[40:43], v[20:23]
    v_lshrrev_b32 v13, 4, v1
    v_lshlrev_b32 v13, 7, v13
    v_and_b32 v15, 7, v1
    v_lshl_add_u32 v13, v15, 2, v13
    s_lshl_b32 s53, s3, 9
    v_add_u32 v220, s53, v13
    v_readfirstlane_b32 s68, v228
    s_nop 4
    v_add_f32 v16, v16, v20
    v_add_f32 v17, v17, v21
    v_add_f32 v18, v18, v22
    v_add_f32 v19, v19, v23
    s_mov_b32 exec_lo, 0x00ff00ff
    s_mov_b32 exec_hi, 0xff00ff00
    ds_write_b32 v220, v16 offset:0
    ds_write_b32 v220, v17 offset:32
    ds_write_b32 v220, v18 offset:64
    ds_write_b32 v220, v19 offset:96
    s_mov_b64 exec, -1
    s_add_u32 s73, s68, 1
    s_and_b32 s68, s73, 0xffff
    s_and_b32 s74, s73, 0xff
    s_waitcnt vmcnt(8)
    s_add_u32 s53, s81, 32768
    s_and_b32 s53, s53, 0xfffff
    buffer_load_dwordx4 v[156:159], v2, s[20:23], s53 offen offset:0 nt
    s_waitcnt vmcnt(8)
    s_add_u32 s53, s81, 32768
    s_and_b32 s53, s53, 0xfffff
    buffer_load_dwordx4 v[160:163], v2, s[20:23], s53 offen offset:256 nt
    s_waitcnt lgkmcnt(0)
    s_barrier
    s_cmp_lg_u32 s3, 0
    s_cbranch_scc1 L_qpub1_alt
    v_lshlrev_b32 v13, 2, v1
    ds_read_b32 v60, v13 offset:0
    ds_read_b32 v61, v13 offset:256
    ds_read_b32 v62, v13 offset:512
    ds_read_b32 v63, v13 offset:768
    ds_read_b32 v64, v13 offset:1024
    ds_read_b32 v65, v13 offset:1280
    ds_read_b32 v66, v13 offset:1536
    ds_read_b32 v67, v13 offset:1792
    s_lshl_b32 s53, s49, 4
    s_add_u32 s53, s53, s48
    s_lshl_b32 s53, s53, 10
    s_lshl_b32 s72, s50, 8
    s_add_u32 s53, s53, s72
    s_add_u32 s53, s53, 1048576
    s_waitcnt lgkmcnt(0)
    v_add_f32 v60, v60, v61
    v_add_f32 v62, v62, v63
    v_add_f32 v64, v64, v65
    v_add_f32 v66, v66, v67
    v_add_f32 v60, v60, v62
    v_add_f32 v64, v64, v66
    v_add_f32 v60, v60, v64
    v_cvt_pk_bf16_f32 v60, v60, v60
    v_lshlrev_b32 v60, 16, v60
    v_or_b32 v60, s68, v60
    buffer_store_dword v60, v13, s[40:43], s53 offen sc1
L_qpub1_alt:
    v_lshrrev_b32 v14, 4, v1
    v_lshlrev_b32 v14, 7, v14
    v_and_b32 v15, 3, v1
    v_lshl_add_u32 v14, v15, 5, v14
    s_lshl_b32 s53, s49, 4
    s_add_u32 s53, s53, s48
    s_lshl_b32 s53, s53, 10
    s_add_u32 s53, s53, 1048576
    v_add_u32 v14, s53, v14
    s_waitcnt vmcnt(8)
    s_add_u32 s53, s81, 32768
    s_and_b32 s53, s53, 0xfffff
    buffer_load_dwordx4 v[164:167], v2, s[20:23], s53 offen offset:2048 nt
    s_waitcnt vmcnt(8)
    s_add_u32 s53, s81, 32768
    s_and_b32 s53, s53, 0xfffff
    buffer_load_dwordx4 v[168:171], v2, s[20:23], s53 offen offset:2304 nt
    s_waitcnt vmcnt(8)
    s_add_u32 s53, s81, 49152
    s_and_b32 s53, s53, 0xfffff
    buffer_load_dwordx4 v[172:175], v2, s[20:23], s53 offen offset:0 nt
    s_waitcnt vmcnt(8)
    s_add_u32 s53, s81, 49152
    s_and_b32 s53, s53, 0xfffff
    buffer_load_dwordx4 v[176:179], v2, s[20:23], s53 offen offset:256 nt
    s_waitcnt vmcnt(8)
    s_add_u32 s53, s81, 49152
    s_and_b32 s53, s53, 0xfffff
    buffer_load_dwordx4 v[180:183], v2, s[20:23], s53 offen offset:2048 nt
    s_waitcnt vmcnt(8)
    s_add_u32 s53, s81, 49152
    s_and_b32 s53, s53, 0xfffff
    buffer_load_dwordx4 v[184:187], v2, s[20:23], s53 offen offset:2304 nt
    s_waitcnt vmcnt(8)
    s_add_u32 s53, s81, 65536
    s_and_b32 s53, s53, 0xfffff
    buffer_load_dwordx4 v[188:191], v2, s[20:23], s53 offen offset:0 nt
    s_waitcnt vmcnt(8)
    s_add_u32 s53, s81, 65536
    s_and_b32 s53, s53, 0xfffff
    buffer_load_dwordx4 v[192:195], v2, s[20:23], s53 offen offset:256 nt
    s_waitcnt vmcnt(8)
    s_add_u32 s53, s81, 65536
    s_and_b32 s53, s53, 0xfffff
    buffer_load_dwordx4 v[196:199], v2, s[20:23], s53 offen offset:2048 nt
    s_waitcnt vmcnt(8)
    s_add_u32 s53, s81, 65536
    s_and_b32 s53, s53, 0xfffff
    buffer_load_dwordx4 v[200:203], v2, s[20:23], s53 offen offset:2304 nt
    s_waitcnt vmcnt(8)
    s_add_u32 s53, s81, 81920
    s_and_b32 s53, s53, 0xfffff
    buffer_load_dwordx4 v[204:207], v2, s[20:23], s53 offen offset:0 nt
    s_waitcnt vmcnt(8)
    s_add_u32 s53, s81, 81920
    s_and_b32 s53, s53, 0xfffff
    buffer_load_dwordx4 v[208:211], v2, s[20:23], s53 offen offset:256 nt
    s_waitcnt vmcnt(8)
    s_add_u32 s53, s81, 81920
    s_and_b32 s53, s53, 0xfffff
    buffer_load_dwordx4 v[212:215], v2, s[20:23], s53 offen offset:2048 nt
    s_waitcnt vmcnt(8)
    s_add_u32 s53, s81, 81920
    s_and_b32 s53, s53, 0xfffff
    buffer_load_dwordx4 v[216:219], v2, s[20:23], s53 offen offset:2304 nt
    buffer_load_dwordx4 v[60:63], v14, s[40:43], 0 offen offset:0 sc1
    buffer_load_dwordx4 v[64:67], v14, s[40:43], 0 offen offset:16 sc1
    buffer_load_dwordx4 v[68:71], v14, s[40:43], 0 offen offset:512 sc1
    buffer_load_dwordx4 v[72:75], v14, s[40:43], 0 offen offset:528 sc1
    s_waitcnt vmcnt(12)
    s_add_u32 s53, s81, 98304
    s_and_b32 s53, s53, 0xfffff
    buffer_load_dwordx4 a[192:195], v2, s[20:23], s53 offen offset:0 nt
    s_waitcnt vmcnt(12)
    s_add_u32 s53, s81, 98304
    s_and_b32 s53, s53, 0xfffff
    buffer_load_dwordx4 a[196:199], v2, s[20:23], s53 offen offset:256 nt
    s_waitcnt vmcnt(12)
    s_add_u32 s53, s81, 98304
    s_and_b32 s53, s53, 0xfffff
    buffer_load_dwordx4 a[200:203], v2, s[20:23], s53 offen offset:2048 nt
    s_waitcnt vmcnt(12)
    s_add_u32 s53, s81, 98304
    s_and_b32 s53, s53, 0xfffff
    buffer_load_dwordx4 a[204:207], v2, s[20:23], s53 offen offset:2304 nt
    s_waitcnt vmcnt(12)
    s_add_u32 s53, s81, 114688
    s_and_b32 s53, s53, 0xfffff
    buffer_load_dwordx4 a[208:211], v2, s[20:23], s53 offen offset:0 nt
    s_waitcnt vmcnt(12)
    s_add_u32 s53, s81, 114688
    s_and_b32 s53, s53, 0xfffff
    buffer_load_dwordx4 a[212:215], v2, s[20:23], s53 offen offset:256 nt
    s_waitcnt vmcnt(6)
    v_xor_b32 v11, s68, v60
    v_xor_b32 v12, s68, v61
    v_xor_b32 v10, s68, v62
    v_or3_b32 v11, v11, v12, v10
    v_xor_b32 v12, s68, v63
    v_xor_b32 v10, s68, v64
    v_or3_b32 v11, v11, v12, v10
    v_xor_b32 v12, s68, v65
    v_xor_b32 v10, s68, v66
    v_or3_b32 v11, v11, v12, v10
    v_xor_b32 v12, s68, v67
    v_xor_b32 v10, s68, v68
    v_or3_b32 v11, v11, v12, v10
    v_xor_b32 v12, s68, v69
    v_xor_b32 v10, s68, v70
    v_or3_b32 v11, v11, v12, v10
    v_xor_b32 v12, s68, v71
    v_xor_b32 v10, s68, v72
    v_or3_b32 v11, v11, v12, v10
    v_xor_b32 v12, s68, v73
    v_xor_b32 v10, s68, v74
    v_or3_b32 v11, v11, v12, v10
    v_xor_b32 v12, s68, v75
    v_or_b32 v11, v11, v12
    v_and_b32 v11, 0xffff, v11
    v_cmp_ne_u32 vcc, 0, v11
    s_nop 4
    s_cbranch_vccnz L_qslow_alt
L_qpack_alt:
    v_perm_b32 v220, v61, v60, s69
    v_perm_b32 v221, v63, v62, s69
    v_perm_b32 v222, v65, v64, s69
    v_perm_b32 v223, v67, v66, s69
    v_perm_b32 v224, v69, v68, s69
    v_perm_b32 v225, v71, v70, s69
    v_perm_b32 v226, v73, v72, s69
    v_perm_b32 v227, v75, v74, s69
L_qready_alt:
    s_add_u32 s53, s81, 114688
    s_and_b32 s53, s53, 0xfffff
    buffer_load_dwordx4 a[216:219], v2, s[20:23], s53 offen offset:2048 nt
    s_add_u32 s53, s81, 114688
    s_and_b32 s53, s53, 0xfffff
    buffer_load_dwordx4 a[220:223], v2, s[20:23], s53 offen offset:2304 nt
    s_add_u32 s53, s81, 131072
    s_and_b32 s53, s53, 0xfffff
    buffer_load_dwordx4 a[224:227], v2, s[20:23], s53 offen offset:0 nt
    s_waitcnt vmcnt(8)
    s_add_u32 s53, s81, 131072
    s_and_b32 s53, s53, 0xfffff
    buffer_load_dwordx4 a[228:231], v2, s[20:23], s53 offen offset:256 nt
    s_waitcnt vmcnt(8)
    s_add_u32 s53, s81, 131072
    s_and_b32 s53, s53, 0xfffff
    buffer_load_dwordx4 a[232:235], v2, s[20:23], s53 offen offset:2048 nt
    s_waitcnt vmcnt(8)
    s_add_u32 s53, s81, 131072
    s_and_b32 s53, s53, 0xfffff
    buffer_load_dwordx4 a[236:239], v2, s[20:23], s53 offen offset:2304 nt
    s_waitcnt vmcnt(8)
    s_add_u32 s53, s81, 147456
    s_and_b32 s53, s53, 0xfffff
    buffer_load_dwordx4 a[240:243], v2, s[20:23], s53 offen offset:0 nt
    s_waitcnt vmcnt(8)
    s_add_u32 s53, s81, 147456
    s_and_b32 s53, s53, 0xfffff
    buffer_load_dwordx4 a[244:247], v2, s[20:23], s53 offen offset:256 nt
    s_waitcnt vmcnt(8)
    s_add_u32 s53, s81, 147456
    s_and_b32 s53, s53, 0xfffff
    buffer_load_dwordx4 a[248:251], v2, s[20:23], s53 offen offset:2048 nt
    s_waitcnt vmcnt(8)
    s_add_u32 s53, s81, 147456
    s_and_b32 s53, s53, 0xfffff
    buffer_load_dwordx4 a[252:255], v2, s[20:23], s53 offen offset:2304 nt
    s_branch L_qmerge
L_qslow_alt:
    s_mov_b32 s71, 4096
L_qpoll_alt:
    buffer_load_dwordx4 v[60:63], v14, s[40:43], 0 offen offset:0 sc1
    buffer_load_dwordx4 v[64:67], v14, s[40:43], 0 offen offset:16 sc1
    buffer_load_dwordx4 v[68:71], v14, s[40:43], 0 offen offset:512 sc1
    buffer_load_dwordx4 v[72:75], v14, s[40:43], 0 offen offset:528 sc1
    s_waitcnt vmcnt(0)
    v_xor_b32 v11, s68, v60
    v_xor_b32 v12, s68, v61
    v_xor_b32 v10, s68, v62
    v_or3_b32 v11, v11, v12, v10
    v_xor_b32 v12, s68, v63
    v_xor_b32 v10, s68, v64
    v_or3_b32 v11, v11, v12, v10
    v_xor_b32 v12, s68, v65
    v_xor_b32 v10, s68, v66
    v_or3_b32 v11, v11, v12, v10
    v_xor_b32 v12, s68, v67
    v_xor_b32 v10, s68, v68
    v_or3_b32 v11, v11, v12, v10
    v_xor_b32 v12, s68, v69
    v_xor_b32 v10, s68, v70
    v_or3_b32 v11, v11, v12, v10
    v_xor_b32 v12, s68, v71
    v_xor_b32 v10, s68, v72
    v_or3_b32 v11, v11, v12, v10
    v_xor_b32 v12, s68, v73
    v_xor_b32 v10, s68, v74
    v_or3_b32 v11, v11, v12, v10
    v_xor_b32 v12, s68, v75
    v_or_b32 v11, v11, v12
    v_and_b32 v11, 0xffff, v11
    v_cmp_ne_u32 vcc, 0, v11
    s_nop 4
    s_cbranch_vccz L_qpack_alt
    s_sub_u32 s71, s71, 1
    s_cmp_lg_u32 s71, 0
    s_cbranch_scc1 L_qpoll_alt
    s_lshl_b32 s70, s3, 13
    v_lshrrev_b32 v13, 4, v1
    v_lshlrev_b32 v13, 7, v13
    v_and_b32 v15, 7, v1
    v_lshl_add_u32 v13, v15, 2, v13
    v_add_u32 v13, s70, v13
    s_mov_b32 s71, 0
L_qfb_alt:
    s_and_b32 s72, s71, 3
    s_mul_i32 s67, s72, 224
    s_mul_i32 s66, s72, 917504
    s_lshr_b32 s72, s71, 2
    s_lshl_b32 s72, s72, 7
    s_add_u32 s66, s66, s72
    v_mov_b32 v16, 0
    v_mov_b32 v17, 0
    v_mov_b32 v18, 0
    v_mov_b32 v19, 0
    v_mov_b32 v20, 0
    v_mov_b32 v21, 0
    v_mov_b32 v22, 0
    v_mov_b32 v23, 0
    buffer_load_dwordx4 v[44:47], v6, s[36:39], s67 offen
    buffer_load_dwordx3 v[48:50], v6, s[36:39], s67 offen offset:16
    buffer_load_dwordx4 a[0:3], v4, s[28:31], s66 offen nt
    s_add_u32 s53, s66, 8192
    buffer_load_dwordx4 a[4:7], v4, s[28:31], s53 offen nt
    s_add_u32 s53, s66, 16384
    buffer_load_dwordx4 a[8:11], v4, s[28:31], s53 offen nt
    s_add_u32 s53, s66, 24576
    buffer_load_dwordx4 a[12:15], v4, s[28:31], s53 offen nt
    s_add_u32 s53, s66, 32768
    buffer_load_dwordx4 a[16:19], v4, s[28:31], s53 offen nt
    s_add_u32 s53, s66, 40960
    buffer_load_dwordx4 a[20:23], v4, s[28:31], s53 offen nt
    s_add_u32 s53, s66, 49152
    buffer_load_dwordx4 a[24:27], v4, s[28:31], s53 offen nt
    s_add_u32 s53, s66, 57344
    buffer_load_dwordx4 a[28:31], v4, s[28:31], s53 offen nt
    s_add_u32 s53, s66, 65536
    buffer_load_dwordx4 a[32:35], v4, s[28:31], s53 offen nt
    s_add_u32 s53, s66, 73728
    buffer_load_dwordx4 a[36:39], v4, s[28:31], s53 offen nt
    s_add_u32 s53, s66, 81920
    buffer_load_dwordx4 a[40:43], v4, s[28:31], s53 offen nt
    s_add_u32 s53, s66, 90112
    buffer_load_dwordx4 a[44:47], v4, s[28:31], s53 offen nt
    s_add_u32 s53, s66, 98304
    buffer_load_dwordx4 a[48:51], v4, s[28:31], s53 offen nt
    s_add_u32 s53, s66, 106496
    buffer_load_dwordx4 a[52:55], v4, s[28:31], s53 offen nt
    s_waitcnt vmcnt(15)
    v_perm_b32 v36, v44, v44, v28
    v_perm_b32 v37, v44, v44, v30
    v_perm_b32 v38, v44, v44, v32
    v_perm_b32 v39, v44, v44, v34
    s_waitcnt vmcnt(13)
    s_nop 1
    v_mfma_f32_16x16x32_bf16 v[16:19], a[0:3], v[36:39], v[16:19]
    v_perm_b32 v40, v44, v44, v29
    v_perm_b32 v41, v44, v44, v31
    v_perm_b32 v42, v44, v44, v33
    v_perm_b32 v43, v44, v44, v35
    s_waitcnt vmcnt(12)
    s_nop 1
    v_mfma_f32_16x16x32_bf16 v[20:23], a[4:7], v[40:43], v[20:23]
    v_perm_b32 v36, v45, v45, v28
    v_perm_b32 v37, v45, v45, v30
    v_perm_b32 v38, v45, v45, v32
    v_perm_b32 v39, v45, v45, v34
    s_waitcnt vmcnt(11)
    s_nop 1
    v_mfma_f32_16x16x32_bf16 v[16:19], a[8:11], v[36:39], v[16:19]
    v_perm_b32 v40, v45, v45, v29
    v_perm_b32 v41, v45, v45, v31
    v_perm_b32 v42, v45, v45, v33
    v_perm_b32 v43, v45, v45, v35
    s_waitcnt vmcnt(10)
    s_nop 1
    v_mfma_f32_16x16x32_bf16 v[20:23], a[12:15], v[40:43], v[20:23]
    v_perm_b32 v36, v46, v46, v28
    v_perm_b32 v37, v46, v46, v30
    v_perm_b32 v38, v46, v46, v32
    v_perm_b32 v39, v46, v46, v34
    s_waitcnt vmcnt(9)
    s_nop 1
    v_mfma_f32_16x16x32_bf16 v[16:19], a[16:19], v[36:39], v[16:19]
    v_perm_b32 v40, v46, v46, v29
    v_perm_b32 v41, v46, v46, v31
    v_perm_b32 v42, v46, v46, v33
    v_perm_b32 v43, v46, v46, v35
    s_waitcnt vmcnt(8)
    s_nop 1
    v_mfma_f32_16x16x32_bf16 v[20:23], a[20:23], v[40:43], v[20:23]
    v_perm_b32 v36, v47, v47, v28
    v_perm_b32 v37, v47, v47, v30
    v_perm_b32 v38, v47, v47, v32
    v_perm_b32 v39, v47, v47, v34
    s_waitcnt vmcnt(7)
    s_nop 1
    v_mfma_f32_16x16x32_bf16 v[16:19], a[24:27], v[36:39], v[16:19]
    v_perm_b32 v40, v47, v47, v29
    v_perm_b32 v41, v47, v47, v31
    v_perm_b32 v42, v47, v47, v33
    v_perm_b32 v43, v47, v47, v35
    s_waitcnt vmcnt(6)
    s_nop 1
    v_mfma_f32_16x16x32_bf16 v[20:23], a[28:31], v[40:43], v[20:23]
    v_perm_b32 v36, v48, v48, v28
    v_perm_b32 v37, v48, v48, v30
    v_perm_b32 v38, v48, v48, v32
    v_perm_b32 v39, v48, v48, v34
    s_waitcnt vmcnt(5)
    s_nop 1
    v_mfma_f32_16x16x32_bf16 v[16:19], a[32:35], v[36:39], v[16:19]
    v_perm_b32 v40, v48, v48, v29
    v_perm_b32 v41, v48, v48, v31
    v_perm_b32 v42, v48, v48, v33
    v_perm_b32 v43, v48, v48, v35
    s_waitcnt vmcnt(4)
    s_nop 1
    v_mfma_f32_16x16x32_bf16 v[20:23], a[36:39], v[40:43], v[20:23]
    v_perm_b32 v36, v49, v49, v28
    v_perm_b32 v37, v49, v49, v30
    v_perm_b32 v38, v49, v49, v32
    v_perm_b32 v39, v49, v49, v34
    s_waitcnt vmcnt(3)
    s_nop 1
    v_mfma_f32_16x16x32_bf16 v[16:19], a[40:43], v[36:39], v[16:19]
    v_perm_b32 v40, v49, v49, v29
    v_perm_b32 v41, v49, v49, v31
    v_perm_b32 v42, v49, v49, v33
    v_perm_b32 v43, v49, v49, v35
    s_waitcnt vmcnt(2)
    s_nop 1
    v_mfma_f32_16x16x32_bf16 v[20:23], a[44:47], v[40:43], v[20:23]
    v_perm_b32 v36, v50, v50, v28
    v_perm_b32 v37, v50, v50, v30
    v_perm_b32 v38, v50, v50, v32
    v_perm_b32 v39, v50, v50, v34
    s_waitcnt vmcnt(1)
    s_nop 1
    v_mfma_f32_16x16x32_bf16 v[16:19], a[48:51], v[36:39], v[16:19]
    v_perm_b32 v40, v50, v50, v29
    v_perm_b32 v41, v50, v50, v31
    v_perm_b32 v42, v50, v50, v33
    v_perm_b32 v43, v50, v50, v35
    s_waitcnt vmcnt(0)
    s_nop 1
    v_mfma_f32_16x16x32_bf16 v[20:23], a[52:55], v[40:43], v[20:23]
    s_nop 7
    v_add_f32 v16, v16, v20
    v_add_f32 v17, v17, v21
    v_add_f32 v18, v18, v22
    v_add_f32 v19, v19, v23
    s_and_b32 s53, s71, 3
    s_lshl_b32 s53, s53, 9
    v_add_u32 v220, s53, v13
    s_mov_b32 exec_lo, 0x00ff00ff
    s_mov_b32 exec_hi, 0xff00ff00
    ds_write_b32 v220, v16 offset:16384
    ds_write_b32 v220, v17 offset:16416
    ds_write_b32 v220, v18 offset:16448
    ds_write_b32 v220, v19 offset:16480
    s_mov_b64 exec, -1
    s_and_b32 s53, s71, 3
    s_cmp_lg_u32 s53, 3
    s_cbranch_scc1 L_qfbn_alt
    v_lshlrev_b32 v220, 3, v1
    v_add_u32 v220, s70, v220
    s_mov_b32 exec_hi, 0
    s_waitcnt lgkmcnt(0)
    ds_read_b64 v[60:61], v220 offset:16384
    ds_read_b64 v[62:63], v220 offset:16640
    ds_read_b64 v[64:65], v220 offset:16896
    ds_read_b64 v[66:67], v220 offset:17152
    ds_read_b64 v[68:69], v220 offset:17408
    ds_read_b64 v[70:71], v220 offset:17664
    ds_read_b64 v[72:73], v220 offset:17920
    ds_read_b64 v[74:75], v220 offset:18176
    s_lshr_b32 s53, s71, 2
    s_lshl_b32 s53, s53, 7
    s_add_u32 s53, s53, s70
    v_lshlrev_b32 v220, 2, v1
    v_add_u32 v220, s53, v220
    s_waitcnt lgkmcnt(0)
    v_add_f32 v60, v60, v62
    v_add_f32 v61, v61, v63
    v_add_f32 v64, v64, v66
    v_add_f32 v65, v65, v67
    v_add_f32 v68, v68, v70
    v_add_f32 v69, v69, v71
    v_add_f32 v72, v72, v74
    v_add_f32 v73, v73, v75
    v_add_f32 v60, v60, v64
    v_add_f32 v61, v61, v65
    v_add_f32 v68, v68, v72
    v_add_f32 v69, v69, v73
    v_add_f32 v60, v60, v68
    v_add_f32 v61, v61, v69
    v_cvt_pk_bf16_f32 v60, v60, v61
    ds_write_b32 v220, v60 offset:18432
    s_mov_b64 exec, -1
    s_waitcnt lgkmcnt(0)
L_qfbn_alt:
    s_add_u32 s71, s71, 1
    s_cmp_lg_u32 s71, 16
    s_cbranch_scc1 L_qfb_alt
    v_lshrrev_b32 v13, 4, v1
    v_lshlrev_b32 v13, 6, v13
    v_and_b32 v15, 3, v1
    v_lshl_add_u32 v13, v15, 4, v13
    v_add_u32 v13, s70, v13
    ds_read_b128 v[220:223], v13 offset:18432
    ds_read_b128 v[224:227], v13 offset:18688
    s_waitcnt vmcnt(0) lgkmcnt(0)
    s_branch L_qready_alt
    s_endpgm
.section .rodata,"a"
.p2align 6
.amdhsa_kernel standalone__mha_block_cached__decode_kernel
  .amdhsa_next_free_vgpr 512
  .amdhsa_next_free_sgpr 102
  .amdhsa_accum_offset 256
  .amdhsa_group_segment_fixed_size 0
  .amdhsa_kernarg_size 64
  .amdhsa_user_sgpr_count 2
  .amdhsa_user_sgpr_kernarg_segment_ptr 1
  .amdhsa_system_sgpr_workgroup_id_x 1
.end_amdhsa_kernel
```
